```python
import torch

def _softmax(x, axis=-1):
    return torch.softmax(x, dim=axis)
def _gelu(x):
    return torch.nn.functional.gelu(x, approximate="tanh")
def _silu(x):
    return torch.nn.functional.silu(x)
def _sigmoid(x):
    return torch.sigmoid(x)
def _layernorm(x, axis=-1, eps=1e-5):
    m = x.mean(dim=axis, keepdim=True)
    v = x.var(dim=axis, keepdim=True, unbiased=False)
    return (x - m) / torch.sqrt(v + eps)
def _scatter_add(tgt, idx, src, axis=0):
    return tgt.clone().index_add_(axis, idx, src)
def _segment_sum(src, seg, n):
    out = torch.zeros((n,) + src.shape[1:], dtype=src.dtype)
    return out.index_add_(0, seg, src)
def _pad(x, pw):
    flat = tuple(v for pair in reversed(pw) for v in pair)
    return torch.nn.functional.pad(x, flat)

kernel_name = 'parallel_sum__sliding_block_cached__dense_activation_relu__decode'

def setup_inputs():

    _w = (lambda a: (lambda t: t.to(torch.bfloat16) if t.is_floating_point() else t)(torch.as_tensor(a)))
    def _A_setup():
        B, Sq, D = 8, 1, 512
        Hq, Hkv, Sk, Dh = 32, 8, 8192, 128
        assert Hq % Hkv == 0, (Hq, Hkv)
        return {
            "x": _w((lambda *s: torch.randn(*s, dtype=torch.bfloat16) * 0.05)(B, Sq, D)),
            "k_cache": _w((lambda *s: torch.randn(*s, dtype=torch.bfloat16) * 3.2)(B, Hkv, Sk, Dh)),
            "v_cache": _w((lambda *s: torch.randn(*s, dtype=torch.bfloat16) * 1.6)(B, Hkv, Sk, Dh)),
            "wq": _w((lambda *s: torch.randn(*s, dtype=torch.bfloat16) * 3.2)(D, Hq * Dh) * (D ** -0.5)),
            "wo": _w((lambda *s: torch.randn(*s, dtype=torch.bfloat16) * 1.6)(Hq * Dh, D) * ((Hq * Dh) ** -0.5)),
        }
    _A_in = _A_setup()

    def _B_setup():
        B, S, D, Dff = 8, 1, 512, 1792
        return {
            "x": _w((lambda *s: torch.randn(*s, dtype=torch.bfloat16) * 0.05)(B, S, D)),
            "w1": _w((lambda *s: torch.randn(*s, dtype=torch.bfloat16) * 0.05)(D, Dff)),
            "w2": _w((lambda *s: torch.randn(*s, dtype=torch.bfloat16) * 0.05)(Dff, D)),
        }
    _B_in = _B_setup()

    return {
        "A_x": _A_in["x"],
        "A_k_cache": _A_in["k_cache"],
        "A_v_cache": _A_in["v_cache"],
        "A_wq": _A_in["wq"],
        "A_wo": _A_in["wo"],
        "B_x": _B_in["x"],
        "B_w1": _B_in["w1"],
        "B_w2": _B_in["w2"],
    }

def reference(A_x, A_k_cache, A_v_cache, A_wq, A_wo, B_x, B_w1, B_w2):
    def _A_ref(x, k_cache, v_cache, wq, wo):
        B, Sq, D = x.shape
        Hq, Dh = 32, 128
        Hkv, Sk = k_cache.shape[1], k_cache.shape[2]
        W = min(4096, max(256, Sk // 4))
        rep = Hq // Hkv
        q = (lambda x, *d: x.permute(*d))((x @ wq).reshape(B, Sq, Hq, Dh), 0, 2, 1, 3)
        k = (lambda x, n, axis: torch.repeat_interleave(x, n, dim=axis))(k_cache[:, :, Sk - W:, :], rep, axis=1)
        v = (lambda x, n, axis: torch.repeat_interleave(x, n, dim=axis))(v_cache[:, :, Sk - W:, :], rep, axis=1)
        scores = torch.einsum("bhqd,bhkd->bhqk", q, k) * (Dh ** -0.5)
        p = _softmax(scores, axis=-1)
        o = torch.einsum("bhqk,bhkd->bhqd", p, v)
        return (lambda x, *d: x.permute(*d))(o, 0, 2, 1, 3).reshape(B, Sq, Hq * Dh) @ wo

    def _B_ref(x, w1, w2):
        h = torch.einsum("bsd,df->bsf", x, w1)
        zero = torch.zeros_like(h)
        h = torch.maximum(h, zero)
        return torch.einsum("bsf,fd->bsd", h, w2)

    x = A_x
    xn = _layernorm(x, axis=-1)
    return x + _A_ref(xn, A_k_cache, A_v_cache, A_wq, A_wo) + _B_ref(xn, B_w1, B_w2)
```

```asm
; @launch grid=(256,1,1) block=(1024,1,1) lds=50176
.amdgcn_target "amdgcn-amd-amdhsa--gfx950"
.text
.globl parallel_sum__sliding_block_cached__dense_activation_relu__decode_kernel
.p2align 8
.type parallel_sum__sliding_block_cached__dense_activation_relu__decode_kernel,@function
parallel_sum__sliding_block_cached__dense_activation_relu__decode_kernel:
s_cmp_ge_u32 s2, 256
s_cbranch_scc1 L_end
s_load_dwordx16 s[4:19], s[0:1], 0
s_load_dwordx4 s[20:23], s[0:1], 64
s_load_dwordx2 s[24:25], s[0:1], 80
s_and_b32 s26, s2, 7
s_lshr_b32 s27, s2, 3
s_xor_b32 s27, s27, 0
s_lshr_b32 s28, s27, 2
s_and_b32 s29, s27, 3
s_lshl_b32 s30, s26, 2
s_add_u32 s30, s30, s29
s_lshl_b32 s32, s28, 3
s_add_u32 s32, s32, s26
s_mov_b32 s34, 0x05040100
s_mov_b32 s35, 0x07060302
s_movk_i32 s3, 15
s_movk_i32 s52, 0xff
v_and_b32 v126, 63, v0
v_mov_b32 v127, 0
v_lshrrev_b32 v1, 6, v0
v_lshlrev_b32 v2, 2, v0
v_readfirstlane_b32 s31, v1
v_cmp_gt_u32 vcc, 32, v0
s_nop 0
s_and_saveexec_b64 s[70:71], vcc
ds_write_b32 v2, v127
s_mov_b64 exec, s[70:71]
s_lshl_b32 s74, s28, 24
s_lshl_b32 s75, s26, 21
s_add_u32 s74, s74, s75
s_add_u32 s74, s74, 1572864
s_and_b32 s33, s31, 7
v_lshrrev_b32 v108, 4, v126
v_and_b32 v111, 7, v126
v_lshlrev_b32 v111, 4, v111
v_bfe_u32 v112, v126, 3, 1
v_lshlrev_b32 v112, 3, v112
v_lshl_add_u32 v112, v108, 4, v112
v_lshlrev_b32 v120, 4, v126
s_and_b32 s75, s33, 3
s_lshl_b32 s75, s75, 10
s_lshr_b32 s76, s33, 2
s_lshl_b32 s76, s76, 16
s_add_u32 s75, s75, s76
s_lshl_b32 s76, s29, 17
s_add_u32 s78, s75, s76
s_mul_i32 s53, s33, 2
s_add_u32 s53, s53, s27
s_and_b32 s53, s53, 15
s_lshl_b32 s53, s53, 12
s_mov_b32 s54, 0xffff
s_mul_i32 s50, s28, 0
s_add_u32 s50, s50, s26
s_and_b32 s50, s50, 7
s_xor_b32 s48, s28, 5
s_xor_b32 s49, s28, 7
s_nop 0
s_lshr_b32 s51, s26, 1
s_and_b32 s64, s26, 1
s_lshl_b32 s64, s64, 2
s_or_b32 s51, s51, s64
s_lshr_b32 s64, s28, 1
s_lshl_b32 s64, s64, 3
s_add_u32 s64, s64, s51
s_and_b32 s65, s28, 1
s_add_u32 s65, s65, 1
s_cmp_ge_u32 s64, 28
s_cselect_b32 s65, 0, s65
s_add_u32 s51, s28, 1
s_waitcnt lgkmcnt(0)
s_cmp_lt_u32 s31, 8
s_cbranch_scc1 L_kwave
s_setprio 3
s_mov_b32 s36, s4
s_mov_b32 s37, s5
s_mov_b32 s38, 8192
s_mov_b32 s39, 0x20000
s_lshl_b32 s75, s33, 10
buffer_load_dwordx4 v[96:99], v120, s[36:39], s75 offen
s_cmp_eq_u32 s33, 0
s_cbranch_scc1 L_setq
s_cmp_lg_u32 s33, 4
s_cbranch_scc1 L_nq1
s_bitcmp0_b32 s65, 0
s_cbranch_scc1 L_nopf
s_mov_b32 s44, s16
s_mov_b32 s45, s17
s_mov_b32 s46, 1835008
s_mov_b32 s47, 0x20000
s_movk_i32 s77, 3584
s_mov_b32 s79, 204288
s_mul_i32 s75, s29, 458752
s_lshl_b32 s76, s64, 7
s_add_u32 s75, s75, s76
s_branch L_tload
L_setq:
s_mov_b32 s44, s10
s_mov_b32 s45, s11
s_mov_b32 s46, 4194304
s_mov_b32 s47, 0x20000
s_mov_b32 s76, 2359296
s_load_dword s68, s[24:25], s76
s_movk_i32 s77, 0x2000
s_mov_b32 s79, 466944
s_lshl_b32 s75, s29, 20
s_lshl_b32 s76, s50, 10
s_add_u32 s75, s75, s76
s_lshl_b32 s76, s48, 7
s_add_u32 s75, s75, s76
L_tload:
v_mul_lo_u32 v121, v112, s77
v_add_u32 v121, v121, v111
buffer_load_dwordx4 v[0:3], v121, s[44:47], s75 offen nt
s_add_u32 s75, s75, s77
buffer_load_dwordx4 v[4:7], v121, s[44:47], s75 offen nt
s_add_u32 s75, s75, s77
buffer_load_dwordx4 v[8:11], v121, s[44:47], s75 offen nt
s_add_u32 s75, s75, s77
buffer_load_dwordx4 v[12:15], v121, s[44:47], s75 offen nt
s_add_u32 s75, s75, s77
buffer_load_dwordx4 v[16:19], v121, s[44:47], s75 offen nt
s_add_u32 s75, s75, s77
buffer_load_dwordx4 v[20:23], v121, s[44:47], s75 offen nt
s_add_u32 s75, s75, s77
buffer_load_dwordx4 v[24:27], v121, s[44:47], s75 offen nt
s_add_u32 s75, s75, s77
buffer_load_dwordx4 v[28:31], v121, s[44:47], s75 offen nt
s_add_u32 s75, s75, s79
buffer_load_dwordx4 v[32:35], v121, s[44:47], s75 offen nt
s_add_u32 s75, s75, s77
buffer_load_dwordx4 v[36:39], v121, s[44:47], s75 offen nt
s_add_u32 s75, s75, s77
buffer_load_dwordx4 v[40:43], v121, s[44:47], s75 offen nt
s_add_u32 s75, s75, s77
buffer_load_dwordx4 v[44:47], v121, s[44:47], s75 offen nt
s_add_u32 s75, s75, s77
buffer_load_dwordx4 v[48:51], v121, s[44:47], s75 offen nt
s_add_u32 s75, s75, s77
buffer_load_dwordx4 v[52:55], v121, s[44:47], s75 offen nt
s_add_u32 s75, s75, s77
buffer_load_dwordx4 v[56:59], v121, s[44:47], s75 offen nt
s_add_u32 s75, s75, s77
buffer_load_dwordx4 v[60:63], v121, s[44:47], s75 offen nt
s_add_u32 s75, s75, s79
s_barrier
s_cmp_lg_u32 s33, 0
s_cbranch_scc1 L_notag
s_waitcnt lgkmcnt(0)
s_add_u32 s68, s68, 1
s_mul_i32 s69, s68, 0x9e3779b1
s_xor_b32 s69, s69, 0x5bd1e995
v_mov_b32 v124, s68
v_mov_b32 v125, s69
ds_write_b64 v127, v[124:125] offset:24
L_notag:
s_waitcnt vmcnt(16)
s_branch L_ln
L_nq1:
s_cmp_lt_u32 s33, 6
s_cbranch_scc1 L_nopf
s_getpc_b64 s[80:81]
L_pc:
s_sub_u32 s80, s80, L_pc-parallel_sum__sliding_block_cached__dense_activation_relu__decode_kernel
s_subb_u32 s81, s81, 0
s_mov_b32 s82, L_codeend-parallel_sum__sliding_block_cached__dense_activation_relu__decode_kernel
s_mov_b32 s83, 0x20000
s_lshl_b32 s75, s29, 1
s_add_u32 s75, s75, s33
s_sub_u32 s75, s75, 6
s_lshl_b32 s75, s75, 11
buffer_load_dwordx4 v[0:3], v120, s[80:83], s75 offen
buffer_load_dwordx4 v[0:3], v120, s[80:83], s75 offen offset:1024
s_barrier
s_waitcnt vmcnt(2)
s_branch L_ln
L_nopf:
s_barrier
s_waitcnt vmcnt(0)
s_branch L_ln
L_kwave:
s_add_u32 s40, s6, s74
s_addc_u32 s41, s7, 0
s_mov_b32 s42, 524288
s_mov_b32 s43, 0x20000
v_bfe_u32 v109, v126, 2, 2
v_and_b32 v110, 3, v126
v_lshlrev_b32 v121, 8, v109
v_lshl_add_u32 v121, v108, 6, v121
v_lshl_add_u32 v121, v110, 4, v121
s_movk_i32 s77, 0x1000
s_barrier
s_add_u32 s55, s78, s53
buffer_load_dwordx4 v[0:3], v121, s[40:43], s55 offen nt
s_add_u32 s53, s53, s77
s_and_b32 s53, s53, s54
s_add_u32 s55, s78, s53
buffer_load_dwordx4 v[4:7], v121, s[40:43], s55 offen nt
s_add_u32 s53, s53, s77
s_and_b32 s53, s53, s54
s_add_u32 s55, s78, s53
buffer_load_dwordx4 v[8:11], v121, s[40:43], s55 offen nt
s_add_u32 s53, s53, s77
s_and_b32 s53, s53, s54
s_add_u32 s55, s78, s53
buffer_load_dwordx4 v[12:15], v121, s[40:43], s55 offen nt
s_add_u32 s53, s53, s77
s_and_b32 s53, s53, s54
s_add_u32 s55, s78, s53
buffer_load_dwordx4 v[16:19], v121, s[40:43], s55 offen nt
s_add_u32 s53, s53, s77
s_and_b32 s53, s53, s54
s_add_u32 s55, s78, s53
buffer_load_dwordx4 v[20:23], v121, s[40:43], s55 offen nt
s_add_u32 s53, s53, s77
s_and_b32 s53, s53, s54
s_add_u32 s55, s78, s53
buffer_load_dwordx4 v[24:27], v121, s[40:43], s55 offen nt
s_add_u32 s53, s53, s77
s_and_b32 s53, s53, s54
s_add_u32 s55, s78, s53
buffer_load_dwordx4 v[28:31], v121, s[40:43], s55 offen nt
s_add_u32 s53, s53, s77
s_and_b32 s53, s53, s54
s_add_u32 s55, s78, s53
buffer_load_dwordx4 v[32:35], v121, s[40:43], s55 offen nt
s_add_u32 s53, s53, s77
s_and_b32 s53, s53, s54
s_add_u32 s55, s78, s53
buffer_load_dwordx4 v[36:39], v121, s[40:43], s55 offen nt
s_add_u32 s53, s53, s77
s_and_b32 s53, s53, s54
s_add_u32 s55, s78, s53
buffer_load_dwordx4 v[40:43], v121, s[40:43], s55 offen nt
s_add_u32 s53, s53, s77
s_and_b32 s53, s53, s54
s_add_u32 s55, s78, s53
buffer_load_dwordx4 v[44:47], v121, s[40:43], s55 offen nt
s_add_u32 s53, s53, s77
s_and_b32 s53, s53, s54
s_add_u32 s55, s78, s53
buffer_load_dwordx4 v[48:51], v121, s[40:43], s55 offen nt
s_add_u32 s53, s53, s77
s_and_b32 s53, s53, s54
s_add_u32 s55, s78, s53
buffer_load_dwordx4 v[52:55], v121, s[40:43], s55 offen nt
s_add_u32 s53, s53, s77
s_and_b32 s53, s53, s54
s_add_u32 s55, s78, s53
buffer_load_dwordx4 v[56:59], v121, s[40:43], s55 offen nt
s_add_u32 s53, s53, s77
s_and_b32 s53, s53, s54
s_add_u32 s55, s78, s53
buffer_load_dwordx4 v[60:63], v121, s[40:43], s55 offen nt
s_add_u32 s53, s53, s77
s_and_b32 s53, s53, s54
s_mov_b32 s56, s24
s_mov_b32 s57, s25
s_mov_b32 s58, 2363392
s_mov_b32 s59, 0x20000
s_mov_b32 s36, s4
s_mov_b32 s37, s5
s_mov_b32 s38, 8192
s_mov_b32 s39, 0x20000
s_mov_b32 s60, s20
s_mov_b32 s61, s21
s_mov_b32 s62, 8192
s_mov_b32 s63, 0x20000
v_lshlrev_b32 v113, 8, v110
v_lshl_add_u32 v113, v108, 6, v113
v_lshl_add_u32 v113, v109, 4, v113
v_lshlrev_b32 v114, 7, v110
v_lshl_add_u32 v114, v108, 5, v114
v_lshl_add_u32 v114, v109, 3, v114
s_lshl_b32 s76, s33, 9
v_add_u32 v114, s76, v114
v_bfe_u32 v116, v126, 2, 3
v_lshlrev_b32 v116, 5, v116
v_lshl_add_u32 v116, v110, 2, v116
s_lshl_b32 s76, s33, 5
v_lshlrev_b32 v117, 2, v126
v_add_u32 v117, s76, v117
s_lshl_b32 s76, s33, 2
v_mov_b32 v123, s76
v_mov_b32 v122, 0
s_mov_b32 s72, 65536
Lw_1:
ds_read_b32 v125, v127 offset:0
s_waitcnt lgkmcnt(0)
v_readfirstlane_b32 s73, v125
s_nop 0
s_cmp_ge_u32 s73, 8
s_nop 1
s_cbranch_scc1 Ld_2
s_sleep 1
s_sub_u32 s72, s72, 1
s_cmp_lg_u32 s72, 0
s_cbranch_scc1 Lw_1
Ld_2:
ds_read_b64 v[124:125], v127 offset:24
s_waitcnt lgkmcnt(0)
v_readfirstlane_b32 s68, v124
v_readfirstlane_b32 s69, v125
s_cmp_ge_u32 s33, 3
s_nop 2
s_cbranch_scc1 L_nog
s_lshl_b32 s84, s26, 12
s_cmp_eq_u32 s33, 1
s_cbranch_scc1 L_gh
s_and_b32 s76, s27, 3
s_lshl_b32 s76, s76, 7
s_add_u32 s79, s84, s76
s_add_u32 s79, s79, 2293760
s_lshl_b32 s75, s28, 14
s_lshl_b32 s76, s26, 11
s_add_u32 s75, s75, s76
s_mov_b32 s66, 131072
s_mov_b32 s67, 0xff800000
s_movk_i32 s77, 1024
v_mov_b32 v122, 8
s_nop 0
s_branch L_g
L_gh:
s_bitcmp0_b32 s65, 1
s_cbranch_scc1 L_nog
s_lshl_b32 s76, s28, 9
s_add_u32 s79, s84, s76
s_add_u32 s79, s79, 2326528
s_lshl_b32 s75, s64, 13
s_add_u32 s75, s75, 2031616
s_movk_i32 s66, 0x800
s_mov_b32 s67, 0
s_movk_i32 s77, 2048
v_mov_b32 v122, 12
L_g:
v_lshlrev_b32 v121, 7, v108
v_add3_u32 v121, v121, v111, s77
v_bfe_u32 v118, v126, 3, 1
v_lshl_add_u32 v121, v118, 3, v121
s_mov_b32 s72, 65536
s_waitcnt vmcnt(0)
s_cmp_lg_u32 s33, 2
s_cbranch_scc1 L_nomode
s_add_u32 s79, s84, 2293760
v_and_b32 v118, 31, v126
v_lshlrev_b32 v118, 7, v118
L_fpoll:
buffer_load_dword v64, v118, s[56:59], s79 offen sc1
s_waitcnt vmcnt(0)
v_xor_b32 v65, s69, v64
v_cmp_lt_u32 vcc, 15, v65
v_readfirstlane_b32 s76, v64
s_mov_b32 s70, 2
s_nop 2
s_cbranch_vccz L_fok
s_sub_u32 s72, s72, 1
s_cmp_lg_u32 s72, 0
s_cbranch_scc1 L_fpoll
s_branch L_fw
L_fok:
v_cmp_ne_u32 vcc, s76, v64
s_nop 0
s_cmp_eq_u64 vcc, 0
s_cselect_b32 s70, 1, 2
L_fw:
v_mov_b32 v118, s70
ds_write_b32 v127, v118 offset:4
s_branch L_nog
L_nomode:
s_mov_b32 s72, 65536
L_qpoll:
s_mov_b32 s76, s75
buffer_load_dwordx4 v[64:67], v120, s[56:59], s76 offen sc1
buffer_load_dwordx4 v[68:71], v120, s[56:59], s76 offen offset:1024 sc1
s_add_u32 s76, s76, s66
buffer_load_dwordx4 v[72:75], v120, s[56:59], s76 offen sc1
buffer_load_dwordx4 v[76:79], v120, s[56:59], s76 offen offset:1024 sc1
s_add_u32 s76, s76, s66
buffer_load_dwordx4 v[80:83], v120, s[56:59], s76 offen sc1
buffer_load_dwordx4 v[84:87], v120, s[56:59], s76 offen offset:1024 sc1
s_add_u32 s76, s76, s66
buffer_load_dwordx4 v[88:91], v120, s[56:59], s76 offen sc1
buffer_load_dwordx4 v[92:95], v120, s[56:59], s76 offen offset:1024 sc1
s_add_u32 s76, s76, s66
s_waitcnt vmcnt(0)
v_xor_b32 v96, s68, v64
v_xor_b32 v97, s68, v65
v_or_b32 v96, v96, v97
v_xor_b32 v97, s68, v66
v_xor_b32 v98, s68, v67
v_or3_b32 v96, v96, v97, v98
v_xor_b32 v97, s68, v68
v_xor_b32 v98, s68, v69
v_or3_b32 v96, v96, v97, v98
v_xor_b32 v97, s68, v70
v_xor_b32 v98, s68, v71
v_or3_b32 v96, v96, v97, v98
v_xor_b32 v97, s68, v72
v_xor_b32 v98, s68, v73
v_or3_b32 v96, v96, v97, v98
v_xor_b32 v97, s68, v74
v_xor_b32 v98, s68, v75
v_or3_b32 v96, v96, v97, v98
v_xor_b32 v97, s68, v76
v_xor_b32 v98, s68, v77
v_or3_b32 v96, v96, v97, v98
v_xor_b32 v97, s68, v78
v_xor_b32 v98, s68, v79
v_or3_b32 v96, v96, v97, v98
v_xor_b32 v97, s68, v80
v_xor_b32 v98, s68, v81
v_or3_b32 v96, v96, v97, v98
v_xor_b32 v97, s68, v82
v_xor_b32 v98, s68, v83
v_or3_b32 v96, v96, v97, v98
v_xor_b32 v97, s68, v84
v_xor_b32 v98, s68, v85
v_or3_b32 v96, v96, v97, v98
v_xor_b32 v97, s68, v86
v_xor_b32 v98, s68, v87
v_or3_b32 v96, v96, v97, v98
v_xor_b32 v97, s68, v88
v_xor_b32 v98, s68, v89
v_or3_b32 v96, v96, v97, v98
v_xor_b32 v97, s68, v90
v_xor_b32 v98, s68, v91
v_or3_b32 v96, v96, v97, v98
v_xor_b32 v97, s68, v92
v_xor_b32 v98, s68, v93
v_or3_b32 v96, v96, v97, v98
v_xor_b32 v97, s68, v94
v_xor_b32 v98, s68, v95
v_or3_b32 v96, v96, v97, v98
v_and_b32 v96, s3, v96
v_cmp_ne_u32 vcc, 0, v96
s_nop 3
s_cbranch_vccz L_qok
s_sub_u32 s72, s72, 1
s_cmp_lg_u32 s72, 0
s_cbranch_scc1 L_qpoll
L_qok:
v_and_b32 v64, 0xfffffff0, v64
v_and_b32 v65, 0xfffffff0, v65
v_and_b32 v66, 0xfffffff0, v66
v_and_b32 v67, 0xfffffff0, v67
v_and_b32 v68, 0xfffffff0, v68
v_and_b32 v69, 0xfffffff0, v69
v_and_b32 v70, 0xfffffff0, v70
v_and_b32 v71, 0xfffffff0, v71
v_and_b32 v72, 0xfffffff0, v72
v_and_b32 v73, 0xfffffff0, v73
v_and_b32 v74, 0xfffffff0, v74
v_and_b32 v75, 0xfffffff0, v75
v_and_b32 v76, 0xfffffff0, v76
v_and_b32 v77, 0xfffffff0, v77
v_and_b32 v78, 0xfffffff0, v78
v_and_b32 v79, 0xfffffff0, v79
v_and_b32 v80, 0xfffffff0, v80
v_and_b32 v81, 0xfffffff0, v81
v_and_b32 v82, 0xfffffff0, v82
v_and_b32 v83, 0xfffffff0, v83
v_and_b32 v84, 0xfffffff0, v84
v_and_b32 v85, 0xfffffff0, v85
v_and_b32 v86, 0xfffffff0, v86
v_and_b32 v87, 0xfffffff0, v87
v_and_b32 v88, 0xfffffff0, v88
v_and_b32 v89, 0xfffffff0, v89
v_and_b32 v90, 0xfffffff0, v90
v_and_b32 v91, 0xfffffff0, v91
v_and_b32 v92, 0xfffffff0, v92
v_and_b32 v93, 0xfffffff0, v93
v_and_b32 v94, 0xfffffff0, v94
v_and_b32 v95, 0xfffffff0, v95
v_add_f32 v64, v64, v72
v_add_f32 v80, v80, v88
v_add_f32 v65, v65, v73
v_add_f32 v81, v81, v89
v_add_f32 v66, v66, v74
v_add_f32 v82, v82, v90
v_add_f32 v67, v67, v75
v_add_f32 v83, v83, v91
v_add_f32 v68, v68, v76
v_add_f32 v84, v84, v92
v_add_f32 v69, v69, v77
v_add_f32 v85, v85, v93
v_add_f32 v70, v70, v78
v_add_f32 v86, v86, v94
v_add_f32 v71, v71, v79
v_add_f32 v87, v87, v95
v_add_f32 v64, v64, v80
v_add_f32 v65, v65, v81
v_add_f32 v66, v66, v82
v_add_f32 v67, v67, v83
v_add_f32 v68, v68, v84
v_add_f32 v69, v69, v85
v_add_f32 v70, v70, v86
v_add_f32 v71, v71, v87
v_max_f32 v64, s67, v64
v_max_f32 v65, s67, v65
v_max_f32 v66, s67, v66
v_max_f32 v67, s67, v67
v_max_f32 v68, s67, v68
v_max_f32 v69, s67, v69
v_max_f32 v70, s67, v70
v_max_f32 v71, s67, v71
v_cvt_pk_bf16_f32 v96, v64, v65
v_cvt_pk_bf16_f32 v97, v66, v67
v_cvt_pk_bf16_f32 v98, v68, v69
v_cvt_pk_bf16_f32 v99, v70, v71
ds_write_b64 v121, v[96:97]
ds_write_b64 v121, v[98:99] offset:512
L_gskip:
s_waitcnt lgkmcnt(0)
v_mov_b32 v125, 1
s_mov_b64 exec, 1
ds_add_u32 v122, v125 offset:0
s_mov_b64 exec, -1
L_nog:
s_mov_b32 s72, 65536
Lw_3:
ds_read_b32 v125, v127 offset:8
s_waitcnt lgkmcnt(0)
v_readfirstlane_b32 s73, v125
s_nop 0
s_cmp_ge_u32 s73, 1
s_nop 1
s_cbranch_scc1 Ld_4
s_sleep 1
s_sub_u32 s72, s72, 1
s_cmp_lg_u32 s72, 0
s_cbranch_scc1 Lw_3
Ld_4:
ds_read_b128 v[96:99], v113 offset:1024
s_waitcnt vmcnt(0) lgkmcnt(0)
v_mfma_f32_16x16x32_bf16 v[100:103], v[0:3], v[96:99], 0
v_mfma_f32_16x16x32_bf16 v[0:3], v[4:7], v[96:99], 0
v_mfma_f32_16x16x32_bf16 v[4:7], v[8:11], v[96:99], 0
v_mfma_f32_16x16x32_bf16 v[8:11], v[12:15], v[96:99], 0
s_nop 4
v_add_f32_dpp v104, v101, v100 row_ror:12 row_mask:0xf bank_mask:0x1
v_mfma_f32_16x16x32_bf16 v[12:15], v[16:19], v[96:99], 0
v_add_f32_dpp v105, v1, v0 row_ror:12 row_mask:0xf bank_mask:0x1
v_add_f32_dpp v104, v102, v104 row_ror:8 row_mask:0xf bank_mask:0x1
v_mfma_f32_16x16x32_bf16 v[16:19], v[20:23], v[96:99], 0
v_add_f32_dpp v106, v5, v4 row_ror:12 row_mask:0xf bank_mask:0x1
v_add_f32_dpp v105, v2, v105 row_ror:8 row_mask:0xf bank_mask:0x1
v_add_f32_dpp v104, v103, v104 row_ror:4 row_mask:0xf bank_mask:0x1
v_mfma_f32_16x16x32_bf16 v[20:23], v[24:27], v[96:99], 0
v_add_f32_dpp v107, v9, v8 row_ror:12 row_mask:0xf bank_mask:0x1
v_add_f32_dpp v106, v6, v106 row_ror:8 row_mask:0xf bank_mask:0x1
v_add_f32_dpp v105, v3, v105 row_ror:4 row_mask:0xf bank_mask:0x1
v_mfma_f32_16x16x32_bf16 v[24:27], v[28:31], v[96:99], 0
v_add_f32_dpp v104, v12, v13 row_ror:4 row_mask:0xf bank_mask:0x2
v_add_f32_dpp v107, v10, v107 row_ror:8 row_mask:0xf bank_mask:0x1
v_add_f32_dpp v106, v7, v106 row_ror:4 row_mask:0xf bank_mask:0x1
v_mfma_f32_16x16x32_bf16 v[28:31], v[32:35], v[96:99], 0
v_add_f32_dpp v105, v16, v17 row_ror:4 row_mask:0xf bank_mask:0x2
v_add_f32_dpp v104, v14, v104 row_ror:12 row_mask:0xf bank_mask:0x2
v_add_f32_dpp v107, v11, v107 row_ror:4 row_mask:0xf bank_mask:0x1
v_mfma_f32_16x16x32_bf16 v[32:35], v[36:39], v[96:99], 0
v_add_f32_dpp v106, v20, v21 row_ror:4 row_mask:0xf bank_mask:0x2
v_add_f32_dpp v105, v18, v105 row_ror:12 row_mask:0xf bank_mask:0x2
v_add_f32_dpp v104, v15, v104 row_ror:8 row_mask:0xf bank_mask:0x2
v_mfma_f32_16x16x32_bf16 v[36:39], v[40:43], v[96:99], 0
v_add_f32_dpp v107, v24, v25 row_ror:4 row_mask:0xf bank_mask:0x2
v_add_f32_dpp v106, v22, v106 row_ror:12 row_mask:0xf bank_mask:0x2
v_add_f32_dpp v105, v19, v105 row_ror:8 row_mask:0xf bank_mask:0x2
v_mfma_f32_16x16x32_bf16 v[40:43], v[44:47], v[96:99], 0
v_add_f32_dpp v104, v28, v30 row_ror:8 row_mask:0xf bank_mask:0x4
v_add_f32_dpp v107, v26, v107 row_ror:12 row_mask:0xf bank_mask:0x2
v_add_f32_dpp v106, v23, v106 row_ror:8 row_mask:0xf bank_mask:0x2
v_mfma_f32_16x16x32_bf16 v[44:47], v[48:51], v[96:99], 0
v_add_f32_dpp v105, v32, v34 row_ror:8 row_mask:0xf bank_mask:0x4
v_add_f32_dpp v104, v29, v104 row_ror:4 row_mask:0xf bank_mask:0x4
v_add_f32_dpp v107, v27, v107 row_ror:8 row_mask:0xf bank_mask:0x2
v_mfma_f32_16x16x32_bf16 v[48:51], v[52:55], v[96:99], 0
v_add_f32_dpp v106, v36, v38 row_ror:8 row_mask:0xf bank_mask:0x4
v_add_f32_dpp v105, v33, v105 row_ror:4 row_mask:0xf bank_mask:0x4
v_add_f32_dpp v104, v31, v104 row_ror:12 row_mask:0xf bank_mask:0x4
v_mfma_f32_16x16x32_bf16 v[52:55], v[56:59], v[96:99], 0
v_add_f32_dpp v107, v40, v42 row_ror:8 row_mask:0xf bank_mask:0x4
v_add_f32_dpp v106, v37, v106 row_ror:4 row_mask:0xf bank_mask:0x4
v_add_f32_dpp v105, v35, v105 row_ror:12 row_mask:0xf bank_mask:0x4
v_mfma_f32_16x16x32_bf16 v[56:59], v[60:63], v[96:99], 0
v_add_f32_dpp v104, v44, v47 row_ror:12 row_mask:0xf bank_mask:0x8
v_add_f32_dpp v107, v41, v107 row_ror:4 row_mask:0xf bank_mask:0x4
v_add_f32_dpp v106, v39, v106 row_ror:12 row_mask:0xf bank_mask:0x4
v_add_f32_dpp v105, v48, v51 row_ror:12 row_mask:0xf bank_mask:0x8
v_add_f32_dpp v104, v45, v104 row_ror:8 row_mask:0xf bank_mask:0x8
v_add_f32_dpp v107, v43, v107 row_ror:12 row_mask:0xf bank_mask:0x4
v_add_f32_dpp v106, v52, v55 row_ror:12 row_mask:0xf bank_mask:0x8
v_add_f32_dpp v105, v49, v105 row_ror:8 row_mask:0xf bank_mask:0x8
v_add_f32_dpp v104, v46, v104 row_ror:4 row_mask:0xf bank_mask:0x8
v_add_f32_dpp v107, v56, v59 row_ror:12 row_mask:0xf bank_mask:0x8
v_add_f32_dpp v106, v53, v106 row_ror:8 row_mask:0xf bank_mask:0x8
v_add_f32_dpp v105, v50, v105 row_ror:4 row_mask:0xf bank_mask:0x8
v_add_f32_dpp v107, v57, v107 row_ror:8 row_mask:0xf bank_mask:0x8
v_add_f32_dpp v106, v54, v106 row_ror:4 row_mask:0xf bank_mask:0x8
s_nop 0
v_add_f32_dpp v107, v58, v107 row_ror:4 row_mask:0xf bank_mask:0x8
s_mov_b32 s76, 0x3db504f3
s_mov_b32 s77, 0x3fb8aa3b
v_cvt_pk_bf16_f32 v0, v104, v105
v_cvt_pk_bf16_f32 v1, v106, v107
v_lshlrev_b32 v2, 16, v0
v_and_b32 v3, 0xffff0000, v0
v_lshlrev_b32 v4, 16, v1
v_and_b32 v5, 0xffff0000, v1
v_mul_f32 v2, s76, v2
v_mul_f32 v3, s76, v3
v_mul_f32 v4, s76, v4
v_mul_f32 v5, s76, v5
v_cvt_pk_bf16_f32 v0, v2, v3
v_cvt_pk_bf16_f32 v1, v4, v5
v_lshlrev_b32 v2, 16, v0
v_and_b32 v3, 0xffff0000, v0
v_lshlrev_b32 v4, 16, v1
v_and_b32 v5, 0xffff0000, v1
v_max3_f32 v6, v2, v3, v4
v_max_f32 v6, v6, v5
s_nop 1
v_max_f32_dpp v6, v6, v6 row_ror:4 row_mask:0xf bank_mask:0xf
s_nop 1
v_max_f32_dpp v6, v6, v6 row_ror:8 row_mask:0xf bank_mask:0xf
v_mov_b32 v7, v6
s_nop 1
v_permlane16_swap_b32 v6, v7
v_max_f32 v6, v6, v7
v_mov_b32 v7, v6
s_nop 1
v_permlane32_swap_b32 v6, v7
v_max_f32 v6, v6, v7
s_mov_b64 exec, 0xf
ds_write_b32 v117, v6 offset:128
s_mov_b64 exec, -1
s_waitcnt lgkmcnt(0)
v_mov_b32 v125, 1
s_mov_b64 exec, 1
ds_add_u32 v127, v125 offset:16
s_mov_b64 exec, -1
s_mov_b32 s72, 65536
Lw_5:
ds_read_b32 v125, v127 offset:16
s_waitcnt lgkmcnt(0)
v_readfirstlane_b32 s73, v125
s_nop 0
s_cmp_ge_u32 s73, 8
s_nop 1
s_cbranch_scc1 Ld_6
s_sleep 1
s_sub_u32 s72, s72, 1
s_cmp_lg_u32 s72, 0
s_cbranch_scc1 Lw_5
Ld_6:
ds_read_b32 v6, v116 offset:128
ds_read_b32 v118, v127 offset:4
s_waitcnt lgkmcnt(0)
v_readfirstlane_b32 s67, v118
v_max_f32_dpp v6, v6, v6 row_ror:4 row_mask:0xf bank_mask:0xf
s_nop 1
v_max_f32_dpp v6, v6, v6 row_ror:8 row_mask:0xf bank_mask:0xf
v_mov_b32 v7, v6
s_nop 1
v_permlane16_swap_b32 v6, v7
v_max_f32 v6, v6, v7
v_sub_f32 v2, v2, v6
v_sub_f32 v3, v3, v6
v_sub_f32 v4, v4, v6
v_sub_f32 v5, v5, v6
v_mul_f32 v2, s77, v2
v_mul_f32 v3, s77, v3
v_mul_f32 v4, s77, v4
v_mul_f32 v5, s77, v5
v_exp_f32 v2, v2
v_exp_f32 v3, v3
v_exp_f32 v4, v4
v_exp_f32 v5, v5
v_cvt_pk_bf16_f32 v0, v2, v3
v_cvt_pk_bf16_f32 v1, v4, v5
ds_write_b64 v114, v[0:1] offset:3072
v_add_f32 v8, v2, v3
v_add_f32 v9, v4, v5
v_add_f32 v8, v8, v9
s_nop 1
v_add_f32_dpp v8, v8, v8 row_ror:4 row_mask:0xf bank_mask:0xf
s_nop 1
v_add_f32_dpp v8, v8, v8 row_ror:8 row_mask:0xf bank_mask:0xf
v_mov_b32 v7, v8
s_nop 1
v_permlane16_swap_b32 v8, v7
v_add_f32 v8, v8, v7
v_mov_b32 v7, v8
s_nop 1
v_permlane32_swap_b32 v8, v7
v_add_f32 v8, v8, v7
v_mov_b32 v11, 1
s_mov_b64 exec, 0xf
ds_write_b32 v117, v8 offset:144
s_mov_b64 exec, -1
s_waitcnt lgkmcnt(0)
s_mov_b64 exec, 1
ds_write_b32 v123, v11 offset:32
ds_add_u32 v127, v11 offset:20
s_mov_b64 exec, -1
s_cmp_lg_u32 s33, 6
s_cbranch_scc1 L_nostat
s_mov_b32 s72, 65536
Lw_7:
ds_read_b32 v125, v127 offset:20
s_waitcnt lgkmcnt(0)
v_readfirstlane_b32 s73, v125
s_nop 0
s_cmp_ge_u32 s73, 8
s_nop 1
s_cbranch_scc1 Ld_8
s_sleep 1
s_sub_u32 s72, s72, 1
s_cmp_lg_u32 s72, 0
s_cbranch_scc1 Lw_7
Ld_8:
ds_read_b32 v8, v116 offset:144
v_mov_b32 v7, s68
v_mov_b32 v9, s69
s_lshl_b32 s76, s32, 9
s_add_u32 s76, s76, 2260992
s_lshl_b32 s75, s29, 4
s_add_u32 s76, s76, s75
v_lshlrev_b32 v10, 7, v126
s_waitcnt lgkmcnt(0)
v_add_f32_dpp v8, v8, v8 row_ror:4 row_mask:0xf bank_mask:0xf
s_nop 1
v_add_f32_dpp v8, v8, v8 row_ror:8 row_mask:0xf bank_mask:0xf
v_mov_b32 v11, v8
s_nop 1
v_permlane16_swap_b32 v8, v11
v_add_f32 v8, v8, v11
s_mov_b64 exec, 0xf
buffer_store_dwordx4 v[6:9], v10, s[56:59], s76 offen sc1
s_mov_b64 exec, -1
L_nostat:
s_cmp_lg_u32 s33, 7
s_cbranch_scc1 L_nofin
v_lshrrev_b32 v108, 3, v126
v_lshrrev_b32 v118, 1, v111
v_lshl_add_u32 v110, v108, 11, v118
v_lshl_add_u32 v112, v108, 14, v111
s_lshl_b32 s87, s28, 16
s_lshl_b32 s76, s30, 6
s_add_u32 s87, s87, s76
s_add_u32 s87, s87, 1048576
s_lshl_b32 s84, s28, 11
s_lshl_b32 s76, s26, 8
s_add_u32 s84, s84, s76
s_lshr_b32 s76, s29, 1
s_lshl_b32 s76, s76, 7
s_add_u32 s84, s84, s76
s_and_b32 s76, s29, 1
s_lshl_b32 s76, s76, 3
s_add_u32 s84, s84, s76
s_add_u32 s84, s84, 1572864
s_lshl_b32 s88, s28, 10
s_lshl_b32 s76, s26, 7
s_add_u32 s88, s88, s76
s_lshl_b32 s76, s29, 2
s_add_u32 s88, s88, s76
buffer_load_dword v20, v111, s[36:39], s88 offen
L_nofin:
v_and_b32 v123, 12, v123
s_mov_b32 s72, 65536
Lw_9:
ds_read_b32 v125, v123 offset:96
s_waitcnt lgkmcnt(0)
v_readfirstlane_b32 s73, v125
s_nop 0
s_cmp_ge_u32 s73, 1
s_nop 1
s_cbranch_scc1 Ld_10
s_sleep 1
s_sub_u32 s72, s72, 1
s_cmp_lg_u32 s72, 0
s_cbranch_scc1 Lw_9
Ld_10:
s_lshl_b32 s82, s33, 3
s_add_u32 s82, s82, s26
s_lshl_b32 s89, s82, 13
s_lshl_b32 s82, s82, 9
s_lshl_b32 s83, s29, 7
s_add_u32 s82, s82, s83
s_add_u32 s82, s82, 2260992
s_lshl_b32 s83, s29, 9
s_add_u32 s89, s89, s83
s_add_u32 s89, s89, 524288
s_add_u32 s90, s89, 4096
s_mov_b32 s72, 65536
L_stpoll:
s_load_dwordx16 s[4:19], s[24:25], s82 glc
s_waitcnt lgkmcnt(0)
s_mov_b32 s73, 0
s_xor_b32 s83, s5, s68
s_or_b32 s73, s73, s83
s_xor_b32 s83, s7, s69
s_or_b32 s73, s73, s83
s_xor_b32 s83, s9, s68
s_or_b32 s73, s73, s83
s_xor_b32 s83, s11, s69
s_or_b32 s73, s73, s83
s_xor_b32 s83, s13, s68
s_or_b32 s73, s73, s83
s_xor_b32 s83, s15, s69
s_or_b32 s73, s73, s83
s_xor_b32 s83, s17, s68
s_or_b32 s73, s73, s83
s_xor_b32 s83, s19, s69
s_or_b32 s73, s73, s83
s_cmp_eq_u32 s73, 0
s_cbranch_scc1 L_stok
s_sleep 12
s_sub_u32 s72, s72, 1
s_cmp_lg_u32 s72, 0
s_cbranch_scc1 L_stpoll
L_stok:
v_mov_b32 v56, s4
v_max_f32 v56, s8, v56
v_max_f32 v56, s12, v56
v_max_f32 v56, s16, v56
v_sub_f32 v52, s4, v56
v_sub_f32 v53, s8, v56
v_sub_f32 v54, s12, v56
v_sub_f32 v55, s16, v56
v_mul_f32 v52, s77, v52
v_mul_f32 v53, s77, v53
v_mul_f32 v54, s77, v54
v_mul_f32 v55, s77, v55
v_exp_f32 v52, v52
v_exp_f32 v53, v53
v_exp_f32 v54, v54
v_exp_f32 v55, v55
v_mul_f32 v56, s6, v52
v_fmac_f32 v56, s10, v53
v_fmac_f32 v56, s14, v54
v_fmac_f32 v56, s18, v55
v_rcp_f32 v56, v56
s_nop 0
v_mul_f32 v52, v52, v56
v_mul_f32 v53, v53, v56
v_mul_f32 v54, v54, v56
v_mul_f32 v55, v55, v56
s_lshl_b32 s76, s33, 8
v_lshlrev_b32 v62, 2, v126
v_add_u32 v62, s76, v62
v_lshlrev_b32 v61, 3, v126
s_mov_b32 s55, 0xffffff00
s_lshl_b32 s78, s32, 2
s_add_u32 s78, s78, s29
s_lshl_b32 s78, s78, 11
s_add_u32 s78, s78, 524288
s_mov_b32 s72, 65536
Lw_11:
ds_read_b32 v125, v127 offset:112
s_waitcnt lgkmcnt(0)
v_readfirstlane_b32 s73, v125
s_nop 0
s_cmp_ge_u32 s73, 8
s_nop 1
s_cbranch_scc1 Ld_12
s_sleep 1
s_sub_u32 s72, s72, 1
s_cmp_lg_u32 s72, 0
s_cbranch_scc1 Lw_11
Ld_12:
buffer_load_dwordx2 v[32:33], v61, s[56:59], s89 offen offset:0 sc1
buffer_load_dwordx2 v[34:35], v61, s[56:59], s89 offen offset:2048 sc1
buffer_load_dwordx2 v[36:37], v61, s[56:59], s90 offen offset:0 sc1
buffer_load_dwordx2 v[38:39], v61, s[56:59], s90 offen offset:2048 sc1
s_cmp_eq_u32 s67, 1
s_barrier
ds_read_b32 v96, v62 offset:15360
ds_read_b32 v97, v62 offset:17408
ds_read_b32 v98, v62 offset:19456
ds_read_b32 v99, v62 offset:21504
s_waitcnt lgkmcnt(2)
v_add_f32 v96, v96, v97
s_waitcnt lgkmcnt(0)
v_add_f32 v98, v98, v99
v_add_f32 v96, v96, v98
v_bfi_b32 v96, s52, v124, v96
s_nop 0
s_cbranch_scc1 L_oxpl
buffer_store_dword v96, v62, s[56:59], s78 offen sc1
s_branch L_oxst
L_oxpl:
buffer_store_dword v96, v62, s[56:59], s78 offen
L_oxst:
s_mov_b32 s72, 65536
s_waitcnt vmcnt(1)
s_branch L_oxc
L_oxpoll:
s_waitcnt vmcnt(0)
L_oxc:
v_bitop3_b32 v48, v32, v33, v124 bitop3:0x7e
v_bitop3_b32 v49, v34, v35, v124 bitop3:0x7e
v_bitop3_b32 v50, v36, v37, v124 bitop3:0x7e
v_bitop3_b32 v51, v38, v39, v124 bitop3:0x7e
v_cmp_ne_u32_sdwa s[4:5], v48, v127 src0_sel:BYTE_0 src1_sel:DWORD
v_cmp_ne_u32_sdwa s[6:7], v49, v127 src0_sel:BYTE_0 src1_sel:DWORD
v_cmp_ne_u32_sdwa s[8:9], v50, v127 src0_sel:BYTE_0 src1_sel:DWORD
v_cmp_ne_u32_sdwa s[10:11], v51, v127 src0_sel:BYTE_0 src1_sel:DWORD
s_or_b64 s[12:13], s[4:5], s[6:7]
s_or_b64 s[14:15], s[8:9], s[10:11]
s_or_b64 s[12:13], s[12:13], s[14:15]
s_nop 0
s_cbranch_scc0 L_oxok
s_cmp_lg_u64 s[4:5], 0
s_cselect_b64 exec, -1, 0
buffer_load_dwordx2 v[32:33], v61, s[56:59], s89 offen offset:0 sc1
s_cmp_lg_u64 s[6:7], 0
s_cselect_b64 exec, -1, 0
buffer_load_dwordx2 v[34:35], v61, s[56:59], s89 offen offset:2048 sc1
s_cmp_lg_u64 s[8:9], 0
s_cselect_b64 exec, -1, 0
buffer_load_dwordx2 v[36:37], v61, s[56:59], s90 offen offset:0 sc1
s_cmp_lg_u64 s[10:11], 0
s_cselect_b64 exec, -1, 0
buffer_load_dwordx2 v[38:39], v61, s[56:59], s90 offen offset:2048 sc1
s_mov_b64 exec, -1
s_sub_u32 s72, s72, 1
s_cmp_lg_u32 s72, 0
s_cbranch_scc1 L_oxpoll
L_oxok:
v_and_b32 v32, s55, v32
v_and_b32 v33, s55, v33
v_and_b32 v34, s55, v34
v_and_b32 v35, s55, v35
v_and_b32 v36, s55, v36
v_and_b32 v37, s55, v37
v_and_b32 v38, s55, v38
v_and_b32 v39, s55, v39
v_mul_f32 v58, v32, v52
v_mul_f32 v59, v33, v52
v_mul_f32 v56, v36, v54
v_mul_f32 v57, v37, v54
v_fmac_f32 v58, v34, v53
v_fmac_f32 v59, v35, v53
v_fmac_f32 v56, v38, v55
v_fmac_f32 v57, v39, v55
L_oxj:
v_add_f32 v58, v58, v56
v_add_f32 v59, v59, v57
v_cvt_pk_bf16_f32 v58, v58, v59
ds_write_b32 v62, v58 offset:31744
s_waitcnt lgkmcnt(0)
s_barrier
s_cmp_eq_u32 s33, 7
s_cbranch_scc1 L_final
s_endpgm
L_final:
s_waitcnt vmcnt(0)
v_and_b32 v38, s52, v124
v_and_b32 v39, s52, v124
s_add_u32 s80, s84, 0
s_add_u32 s81, s84, 131072
s_add_u32 s82, s84, 262144
s_add_u32 s83, s84, 393216
buffer_load_dwordx2 v[32:33], v112, s[56:59], s80 offen sc1
buffer_load_dwordx2 v[34:35], v112, s[56:59], s81 offen sc1
buffer_load_dwordx2 v[36:37], v112, s[56:59], s82 offen sc1
s_mov_b32 exec_hi, 0
buffer_load_dwordx2 v[38:39], v112, s[56:59], s83 offen sc1
s_mov_b64 exec, -1
s_mov_b32 s72, 65536
L_obpoll:
s_waitcnt vmcnt(0)
L_obc:
v_bitop3_b32 v48, v32, v33, v124 bitop3:0x7e
v_bitop3_b32 v49, v34, v35, v124 bitop3:0x7e
v_bitop3_b32 v50, v36, v37, v124 bitop3:0x7e
v_bitop3_b32 v51, v38, v39, v124 bitop3:0x7e
v_cmp_ne_u32_sdwa s[4:5], v48, v127 src0_sel:BYTE_0 src1_sel:DWORD
v_cmp_ne_u32_sdwa s[6:7], v49, v127 src0_sel:BYTE_0 src1_sel:DWORD
v_cmp_ne_u32_sdwa s[8:9], v50, v127 src0_sel:BYTE_0 src1_sel:DWORD
v_cmp_ne_u32_sdwa s[10:11], v51, v127 src0_sel:BYTE_0 src1_sel:DWORD
s_or_b64 s[12:13], s[4:5], s[6:7]
s_or_b64 s[14:15], s[8:9], s[10:11]
s_or_b64 s[12:13], s[12:13], s[14:15]
s_nop 0
s_cbranch_scc0 L_obok
s_cmp_lg_u64 s[4:5], 0
s_cselect_b64 exec, -1, 0
buffer_load_dwordx2 v[32:33], v112, s[56:59], s80 offen sc1
s_cmp_lg_u64 s[6:7], 0
s_cselect_b64 exec, -1, 0
buffer_load_dwordx2 v[34:35], v112, s[56:59], s81 offen sc1
s_cmp_lg_u64 s[8:9], 0
s_cselect_b64 exec, -1, 0
buffer_load_dwordx2 v[36:37], v112, s[56:59], s82 offen sc1
s_cmp_lg_u64 s[10:11], 0
s_cselect_b64 exec, -1, 0
s_mov_b32 exec_hi, 0
buffer_load_dwordx2 v[38:39], v112, s[56:59], s83 offen sc1
s_mov_b64 exec, -1
s_sub_u32 s72, s72, 1
s_cmp_lg_u32 s72, 0
s_cbranch_scc1 L_obpoll
L_obok:
v_and_b32 v32, s55, v32
v_and_b32 v33, s55, v33
v_and_b32 v34, s55, v34
v_and_b32 v35, s55, v35
v_and_b32 v36, s55, v36
v_and_b32 v37, s55, v37
v_and_b32 v38, s55, v38
v_and_b32 v39, s55, v39
v_add_f32 v56, v32, v34
v_add_f32 v57, v33, v35
v_add_f32 v58, v36, v38
v_add_f32 v59, v37, v39
L_obj:
v_add_f32 v22, v56, v58
v_add_f32 v23, v57, v59
s_nop 0
v_add_f32_dpp v22, v22, v22 row_ror:8 row_mask:0xf bank_mask:0xf
v_add_f32_dpp v23, v23, v23 row_ror:8 row_mask:0xf bank_mask:0xf
v_mov_b32 v48, v22
v_mov_b32 v49, v23
s_nop 0
v_permlane16_swap_b32 v22, v48
v_permlane16_swap_b32 v23, v49
v_add_f32 v22, v22, v48
v_add_f32 v23, v23, v49
v_mov_b32 v48, v22
v_mov_b32 v49, v23
s_nop 0
v_permlane32_swap_b32 v22, v48
v_permlane32_swap_b32 v23, v49
v_add_f32 v22, v22, v48
v_add_f32 v23, v23, v49
v_cvt_pk_bf16_f32 v48, v22, v23
v_lshlrev_b32 v22, 16, v48
v_and_b32 v23, 0xffff0000, v48
v_and_b32 v21, 0xffff0000, v20
v_lshlrev_b32 v20, 16, v20
s_waitcnt vmcnt(0)
s_add_u32 s80, s87, 0
s_add_u32 s81, s87, 16384
s_add_u32 s82, s87, 32768
s_add_u32 s83, s87, 49152
buffer_load_dwordx2 v[32:33], v110, s[56:59], s80 offen sc1
buffer_load_dwordx2 v[34:35], v110, s[56:59], s81 offen sc1
buffer_load_dwordx2 v[36:37], v110, s[56:59], s82 offen sc1
buffer_load_dwordx2 v[38:39], v110, s[56:59], s83 offen sc1
s_mov_b32 s72, 65536
s_waitcnt vmcnt(0)
v_bitop3_b32 v48, v32, v33, v124 bitop3:0x7e
v_bitop3_b32 v49, v34, v35, v124 bitop3:0x7e
v_bitop3_b32 v50, v36, v37, v124 bitop3:0x7e
v_bitop3_b32 v51, v38, v39, v124 bitop3:0x7e
v_cmp_ne_u32_sdwa s[4:5], v48, v127 src0_sel:BYTE_0 src1_sel:DWORD
v_cmp_ne_u32_sdwa s[6:7], v49, v127 src0_sel:BYTE_0 src1_sel:DWORD
v_cmp_ne_u32_sdwa s[8:9], v50, v127 src0_sel:BYTE_0 src1_sel:DWORD
v_cmp_ne_u32_sdwa s[10:11], v51, v127 src0_sel:BYTE_0 src1_sel:DWORD
s_or_b64 s[12:13], s[4:5], s[6:7]
s_or_b64 s[14:15], s[8:9], s[10:11]
s_or_b64 s[12:13], s[12:13], s[14:15]
s_nop 0
s_cbranch_scc0 L_oaok
v_mov_b32 v40, v32
v_mov_b32 v41, v33
v_mov_b32 v42, v34
v_mov_b32 v43, v35
v_mov_b32 v44, v36
v_mov_b32 v45, v37
v_mov_b32 v46, v38
v_mov_b32 v47, v39
s_cmp_lg_u64 s[4:5], 0
s_cselect_b64 exec, -1, 0
buffer_load_dwordx2 v[32:33], v110, s[56:59], s80 offen sc1
s_cmp_lg_u64 s[6:7], 0
s_cselect_b64 exec, -1, 0
buffer_load_dwordx2 v[34:35], v110, s[56:59], s81 offen sc1
s_cmp_lg_u64 s[8:9], 0
s_cselect_b64 exec, -1, 0
buffer_load_dwordx2 v[36:37], v110, s[56:59], s82 offen sc1
s_cmp_lg_u64 s[10:11], 0
s_cselect_b64 exec, -1, 0
buffer_load_dwordx2 v[38:39], v110, s[56:59], s83 offen sc1
s_mov_b64 exec, -1
s_sleep 4
s_cmp_lg_u64 s[4:5], 0
s_cselect_b64 exec, -1, 0
buffer_load_dwordx2 v[40:41], v110, s[56:59], s80 offen sc1
s_cmp_lg_u64 s[6:7], 0
s_cselect_b64 exec, -1, 0
buffer_load_dwordx2 v[42:43], v110, s[56:59], s81 offen sc1
s_cmp_lg_u64 s[8:9], 0
s_cselect_b64 exec, -1, 0
buffer_load_dwordx2 v[44:45], v110, s[56:59], s82 offen sc1
s_cmp_lg_u64 s[10:11], 0
s_cselect_b64 exec, -1, 0
buffer_load_dwordx2 v[46:47], v110, s[56:59], s83 offen sc1
s_mov_b64 exec, -1
L_oapoll:
s_waitcnt vmcnt(4)
v_bitop3_b32 v48, v32, v33, v124 bitop3:0x7e
v_bitop3_b32 v49, v34, v35, v124 bitop3:0x7e
v_bitop3_b32 v50, v36, v37, v124 bitop3:0x7e
v_bitop3_b32 v51, v38, v39, v124 bitop3:0x7e
v_cmp_ne_u32_sdwa s[4:5], v48, v127 src0_sel:BYTE_0 src1_sel:DWORD
v_cmp_ne_u32_sdwa s[6:7], v49, v127 src0_sel:BYTE_0 src1_sel:DWORD
v_cmp_ne_u32_sdwa s[8:9], v50, v127 src0_sel:BYTE_0 src1_sel:DWORD
v_cmp_ne_u32_sdwa s[10:11], v51, v127 src0_sel:BYTE_0 src1_sel:DWORD
s_or_b64 s[12:13], s[4:5], s[6:7]
s_or_b64 s[14:15], s[8:9], s[10:11]
s_or_b64 s[12:13], s[12:13], s[14:15]
s_nop 0
s_cbranch_scc0 L_oaok
s_cmp_lg_u64 s[4:5], 0
s_cselect_b64 exec, -1, 0
buffer_load_dwordx2 v[32:33], v110, s[56:59], s80 offen sc1
s_cmp_lg_u64 s[6:7], 0
s_cselect_b64 exec, -1, 0
buffer_load_dwordx2 v[34:35], v110, s[56:59], s81 offen sc1
s_cmp_lg_u64 s[8:9], 0
s_cselect_b64 exec, -1, 0
buffer_load_dwordx2 v[36:37], v110, s[56:59], s82 offen sc1
s_cmp_lg_u64 s[10:11], 0
s_cselect_b64 exec, -1, 0
buffer_load_dwordx2 v[38:39], v110, s[56:59], s83 offen sc1
s_mov_b64 exec, -1
s_waitcnt vmcnt(4)
v_bitop3_b32 v48, v40, v41, v124 bitop3:0x7e
v_bitop3_b32 v49, v42, v43, v124 bitop3:0x7e
v_bitop3_b32 v50, v44, v45, v124 bitop3:0x7e
v_bitop3_b32 v51, v46, v47, v124 bitop3:0x7e
v_cmp_ne_u32_sdwa s[4:5], v48, v127 src0_sel:BYTE_0 src1_sel:DWORD
v_cmp_ne_u32_sdwa s[6:7], v49, v127 src0_sel:BYTE_0 src1_sel:DWORD
v_cmp_ne_u32_sdwa s[8:9], v50, v127 src0_sel:BYTE_0 src1_sel:DWORD
v_cmp_ne_u32_sdwa s[10:11], v51, v127 src0_sel:BYTE_0 src1_sel:DWORD
s_or_b64 s[12:13], s[4:5], s[6:7]
s_or_b64 s[14:15], s[8:9], s[10:11]
s_or_b64 s[12:13], s[12:13], s[14:15]
s_nop 0
s_cbranch_scc0 L_oaokb
s_cmp_lg_u64 s[4:5], 0
s_cselect_b64 exec, -1, 0
buffer_load_dwordx2 v[40:41], v110, s[56:59], s80 offen sc1
s_cmp_lg_u64 s[6:7], 0
s_cselect_b64 exec, -1, 0
buffer_load_dwordx2 v[42:43], v110, s[56:59], s81 offen sc1
s_cmp_lg_u64 s[8:9], 0
s_cselect_b64 exec, -1, 0
buffer_load_dwordx2 v[44:45], v110, s[56:59], s82 offen sc1
s_cmp_lg_u64 s[10:11], 0
s_cselect_b64 exec, -1, 0
buffer_load_dwordx2 v[46:47], v110, s[56:59], s83 offen sc1
s_mov_b64 exec, -1
s_sub_u32 s72, s72, 1
s_cmp_lg_u32 s72, 0
s_cbranch_scc1 L_oapoll
L_oaokb:
v_and_b32 v40, s55, v40
v_and_b32 v41, s55, v41
v_and_b32 v42, s55, v42
v_and_b32 v43, s55, v43
v_and_b32 v44, s55, v44
v_and_b32 v45, s55, v45
v_and_b32 v46, s55, v46
v_and_b32 v47, s55, v47
v_add_f32 v56, v40, v42
v_add_f32 v57, v41, v43
v_add_f32 v58, v44, v46
v_add_f32 v59, v45, v47
s_nop 0
s_branch L_oaj
L_oaok:
v_and_b32 v32, s55, v32
v_and_b32 v33, s55, v33
v_and_b32 v34, s55, v34
v_and_b32 v35, s55, v35
v_and_b32 v36, s55, v36
v_and_b32 v37, s55, v37
v_and_b32 v38, s55, v38
v_and_b32 v39, s55, v39
v_add_f32 v56, v32, v34
v_add_f32 v57, v33, v35
v_add_f32 v58, v36, v38
v_add_f32 v59, v37, v39
L_oaj:
v_add_f32 v24, v56, v58
v_add_f32 v25, v57, v59
s_nop 0
v_add_f32_dpp v24, v24, v24 row_ror:8 row_mask:0xf bank_mask:0xf
v_add_f32_dpp v25, v25, v25 row_ror:8 row_mask:0xf bank_mask:0xf
v_mov_b32 v48, v24
v_mov_b32 v49, v25
s_nop 0
v_permlane16_swap_b32 v24, v48
v_permlane16_swap_b32 v25, v49
v_add_f32 v24, v24, v48
v_add_f32 v25, v25, v49
v_mov_b32 v48, v24
v_mov_b32 v49, v25
s_nop 0
v_permlane32_swap_b32 v24, v48
v_permlane32_swap_b32 v25, v49
v_add_f32 v24, v24, v48
v_add_f32 v25, v25, v49
v_cvt_pk_bf16_f32 v48, v24, v25
v_lshlrev_b32 v24, 16, v48
v_and_b32 v25, 0xffff0000, v48
v_add_f32 v20, v20, v24
v_add_f32 v21, v21, v25
v_cvt_pk_bf16_f32 v16, v20, v21
v_lshlrev_b32 v20, 16, v16
v_and_b32 v21, 0xffff0000, v16
v_add_f32 v20, v20, v22
v_add_f32 v21, v21, v23
v_cvt_pk_bf16_f32 v20, v20, v21
s_mov_b64 exec, 0xff
buffer_store_dword v20, v111, s[60:63], s88 offen
s_mov_b64 exec, -1
s_cmp_lg_u32 s2, 0
s_cbranch_scc1 L_end
s_mov_b32 s76, 2359296
s_mov_b64 exec, 1
buffer_store_dword v124, v127, s[56:59], s76 offen
s_endpgm
L_ln:
v_lshlrev_b32 v100, 16, v96
v_and_b32 v101, 0xffff0000, v96
v_lshlrev_b32 v102, 16, v97
v_and_b32 v103, 0xffff0000, v97
v_lshlrev_b32 v104, 16, v98
v_and_b32 v105, 0xffff0000, v98
v_lshlrev_b32 v106, 16, v99
v_and_b32 v107, 0xffff0000, v99
v_add_f32 v96, v100, v101
v_add_f32 v97, v102, v103
v_add_f32 v98, v104, v105
v_add_f32 v99, v106, v107
v_add_f32 v96, v96, v97
v_add_f32 v98, v98, v99
v_add_f32 v96, v96, v98
s_nop 1
v_add_f32_dpp v96, v96, v96 row_ror:8 row_mask:0xf bank_mask:0xf
s_nop 1
v_add_f32_dpp v96, v96, v96 row_ror:4 row_mask:0xf bank_mask:0xf
s_nop 1
v_add_f32_dpp v96, v96, v96 row_ror:2 row_mask:0xf bank_mask:0xf
s_nop 1
v_add_f32_dpp v96, v96, v96 row_ror:1 row_mask:0xf bank_mask:0xf
v_mov_b32 v97, v96
s_nop 1
v_permlane16_swap_b32 v96, v97
v_add_f32 v96, v96, v97
v_mov_b32 v97, v96
s_nop 1
v_permlane32_swap_b32 v96, v97
v_add_f32 v96, v96, v97
v_mul_f32 v96, 0x3b000000, v96
v_sub_f32 v98, v100, v96
v_mul_f32 v97, v98, v98
v_sub_f32 v98, v101, v96
v_fmac_f32 v97, v98, v98
v_sub_f32 v98, v102, v96
v_fmac_f32 v97, v98, v98
v_sub_f32 v98, v103, v96
v_fmac_f32 v97, v98, v98
v_sub_f32 v98, v104, v96
v_fmac_f32 v97, v98, v98
v_sub_f32 v98, v105, v96
v_fmac_f32 v97, v98, v98
v_sub_f32 v98, v106, v96
v_fmac_f32 v97, v98, v98
v_sub_f32 v98, v107, v96
v_fmac_f32 v97, v98, v98
s_nop 1
v_add_f32_dpp v97, v97, v97 row_ror:8 row_mask:0xf bank_mask:0xf
s_nop 1
v_add_f32_dpp v97, v97, v97 row_ror:4 row_mask:0xf bank_mask:0xf
s_nop 1
v_add_f32_dpp v97, v97, v97 row_ror:2 row_mask:0xf bank_mask:0xf
s_nop 1
v_add_f32_dpp v97, v97, v97 row_ror:1 row_mask:0xf bank_mask:0xf
v_mov_b32 v98, v97
s_nop 1
v_permlane16_swap_b32 v97, v98
v_add_f32 v97, v97, v98
v_mov_b32 v98, v97
s_nop 1
v_permlane32_swap_b32 v97, v98
v_add_f32 v97, v97, v98
v_mul_f32 v97, 0x3b000000, v97
v_cvt_pk_bf16_f32 v96, v96, v96
v_lshlrev_b32 v96, 16, v96
v_cvt_pk_bf16_f32 v97, v97, v97
v_lshlrev_b32 v97, 16, v97
v_add_f32 v97, 0x3727c5ac, v97
v_cvt_pk_bf16_f32 v97, v97, v97
v_lshlrev_b32 v97, 16, v97
v_sqrt_f32 v97, v97
s_nop 0
v_cvt_pk_bf16_f32 v97, v97, v97
v_lshlrev_b32 v97, 16, v97
v_rcp_f32 v98, v97
v_sub_f32 v100, v100, v96
v_sub_f32 v101, v101, v96
v_cvt_pk_bf16_f32 v99, v100, v101
v_lshlrev_b32 v100, 16, v99
v_and_b32 v101, 0xffff0000, v99
v_sub_f32 v102, v102, v96
v_sub_f32 v103, v103, v96
v_cvt_pk_bf16_f32 v99, v102, v103
v_lshlrev_b32 v102, 16, v99
v_and_b32 v103, 0xffff0000, v99
v_sub_f32 v104, v104, v96
v_sub_f32 v105, v105, v96
v_cvt_pk_bf16_f32 v99, v104, v105
v_lshlrev_b32 v104, 16, v99
v_and_b32 v105, 0xffff0000, v99
v_sub_f32 v106, v106, v96
v_sub_f32 v107, v107, v96
v_cvt_pk_bf16_f32 v99, v106, v107
v_lshlrev_b32 v106, 16, v99
v_and_b32 v107, 0xffff0000, v99
v_mul_f32 v99, v100, v98
v_fma_f32 v100, -v99, v97, v100
v_fma_f32 v100, v100, v98, v99
v_mul_f32 v99, v101, v98
v_fma_f32 v101, -v99, v97, v101
v_fma_f32 v101, v101, v98, v99
v_mul_f32 v99, v102, v98
v_fma_f32 v102, -v99, v97, v102
v_fma_f32 v102, v102, v98, v99
v_mul_f32 v99, v103, v98
v_fma_f32 v103, -v99, v97, v103
v_fma_f32 v103, v103, v98, v99
v_mul_f32 v99, v104, v98
v_fma_f32 v104, -v99, v97, v104
v_fma_f32 v104, v104, v98, v99
v_mul_f32 v99, v105, v98
v_fma_f32 v105, -v99, v97, v105
v_fma_f32 v105, v105, v98, v99
v_mul_f32 v99, v106, v98
v_fma_f32 v106, -v99, v97, v106
v_fma_f32 v106, v106, v98, v99
v_mul_f32 v99, v107, v98
v_fma_f32 v107, -v99, v97, v107
v_fma_f32 v107, v107, v98, v99
v_cvt_pk_bf16_f32 v96, v100, v101
v_cvt_pk_bf16_f32 v97, v102, v103
v_cvt_pk_bf16_f32 v98, v104, v105
v_cvt_pk_bf16_f32 v99, v106, v107
s_lshl_b32 s75, s33, 10
v_add_u32 v122, s75, v120
ds_write_b128 v122, v[96:99] offset:7168
s_waitcnt lgkmcnt(0)
v_mov_b32 v125, 1
s_mov_b64 exec, 1
ds_add_u32 v127, v125 offset:0
s_mov_b64 exec, -1
s_mov_b32 s56, s24
s_mov_b32 s57, s25
s_mov_b32 s58, 2363392
s_mov_b32 s59, 0x20000
s_add_u32 s40, s8, s74
s_addc_u32 s41, s9, 0
s_mov_b32 s42, 524288
s_mov_b32 s43, 0x20000
v_mov_b32 v119, 0
s_mov_b32 s66, 0
s_cmp_eq_u32 s33, 0
s_cbranch_scc1 L_tq
s_cmp_lt_u32 s33, 3
s_cbranch_scc1 L_f2l
s_cmp_lg_u32 s33, 4
s_cbranch_scc1 L_vload
s_bitcmp0_b32 s65, 0
s_cbranch_scc1 L_vload
v_lshrrev_b32 v121, 3, v126
v_lshlrev_b32 v123, 7, v121
v_lshlrev_b32 v121, 8, v121
v_lshrrev_b32 v122, 2, v111
v_add_u32 v123, v123, v122
s_lshl_b32 s75, s64, 2
s_add_u32 s75, s75, s29
s_lshl_b32 s75, s75, 11
s_add_u32 s75, s75, 2031616
s_lshl_b32 s76, s26, 12
s_lshl_b32 s77, s51, 9
s_add_u32 s76, s76, s77
s_lshl_b32 s77, s29, 5
s_add_u32 s76, s76, s77
s_add_u32 s76, s76, 2326528
s_movk_i32 s70, 0
s_branch L_tile
L_tq:
v_lshrrev_b32 v121, 3, v126
v_lshlrev_b32 v121, 14, v121
v_lshlrev_b32 v123, 7, v126
s_lshl_b32 s75, s29, 17
s_lshl_b32 s76, s50, 11
s_add_u32 s75, s75, s76
s_lshl_b32 s77, s48, 8
s_add_u32 s75, s75, s77
s_lshl_b32 s76, s50, 12
s_lshl_b32 s77, s27, 7
s_add_u32 s76, s76, s77
s_add_u32 s76, s76, 2293760
s_mov_b32 s70, 1
L_tile:
s_mov_b32 s71, 0
v_add_u32 v121, v111, v121
v_bfe_u32 v122, v126, 1, 3
v_lshlrev_b32 v122, 10, v122
v_and_b32 v118, 1, v126
v_lshl_add_u32 v122, v118, 4, v122
v_lshrrev_b32 v118, 4, v126
v_lshl_add_u32 v122, v118, 5, v122
s_lshl_b32 s77, s29, 8
v_add_u32 v122, s77, v122
s_mov_b32 s72, 65536
Lw_13:
ds_read_b32 v125, v127 offset:0
s_waitcnt lgkmcnt(0)
v_readfirstlane_b32 s73, v125
s_nop 0
s_cmp_ge_u32 s73, 8
s_nop 1
s_cbranch_scc1 Ld_14
s_sleep 1
s_sub_u32 s72, s72, 1
s_cmp_lg_u32 s72, 0
s_cbranch_scc1 Lw_13
Ld_14:
ds_read_b128 v[96:99], v122 offset:7168
ds_read_b128 v[100:103], v122 offset:7296
ds_read_b64 v[124:125], v127 offset:24
s_waitcnt lgkmcnt(0)
v_readfirstlane_b32 s68, v124
v_readfirstlane_b32 s69, v125
s_getreg_b32 s77, hwreg(HW_REG_XCC_ID)
s_and_b32 s77, s77, 15
s_andn2_b32 s79, s69, 15
s_or_b32 s77, s77, s79
v_mov_b32 v122, s77
s_waitcnt vmcnt(8)
v_perm_b32 v104, v4, v0, s34
v_perm_b32 v105, v12, v8, s34
v_perm_b32 v106, v20, v16, s34
v_perm_b32 v107, v28, v24, s34
v_perm_b32 v108, v4, v0, s35
v_perm_b32 v109, v12, v8, s35
v_perm_b32 v110, v20, v16, s35
v_perm_b32 v111, v28, v24, s35
v_mfma_f32_16x16x32_bf16 v[64:67], v[96:99], v[104:107], 0
s_nop 0
v_mfma_f32_16x16x32_bf16 v[68:71], v[96:99], v[108:111], 0
v_perm_b32 v112, v5, v1, s34
v_perm_b32 v113, v13, v9, s34
v_perm_b32 v114, v21, v17, s34
v_perm_b32 v115, v29, v25, s34
v_perm_b32 v116, v5, v1, s35
v_perm_b32 v117, v13, v9, s35
v_perm_b32 v118, v21, v17, s35
v_perm_b32 v119, v29, v25, s35
v_mfma_f32_16x16x32_bf16 v[72:75], v[96:99], v[112:115], 0
s_nop 0
v_mfma_f32_16x16x32_bf16 v[76:79], v[96:99], v[116:119], 0
v_perm_b32 v104, v6, v2, s34
v_perm_b32 v105, v14, v10, s34
v_perm_b32 v106, v22, v18, s34
v_perm_b32 v107, v30, v26, s34
v_perm_b32 v108, v6, v2, s35
v_perm_b32 v109, v14, v10, s35
v_perm_b32 v110, v22, v18, s35
v_perm_b32 v111, v30, v26, s35
v_mfma_f32_16x16x32_bf16 v[80:83], v[96:99], v[104:107], 0
s_nop 0
v_mfma_f32_16x16x32_bf16 v[84:87], v[96:99], v[108:111], 0
v_perm_b32 v112, v7, v3, s34
v_perm_b32 v113, v15, v11, s34
v_perm_b32 v114, v23, v19, s34
v_perm_b32 v115, v31, v27, s34
v_perm_b32 v116, v7, v3, s35
v_perm_b32 v117, v15, v11, s35
v_perm_b32 v118, v23, v19, s35
v_perm_b32 v119, v31, v27, s35
v_mfma_f32_16x16x32_bf16 v[88:91], v[96:99], v[112:115], 0
s_nop 0
v_mfma_f32_16x16x32_bf16 v[92:95], v[96:99], v[116:119], 0
s_waitcnt vmcnt(0)
v_perm_b32 v104, v36, v32, s34
v_perm_b32 v105, v44, v40, s34
v_perm_b32 v106, v52, v48, s34
v_perm_b32 v107, v60, v56, s34
v_perm_b32 v108, v36, v32, s35
v_perm_b32 v109, v44, v40, s35
v_perm_b32 v110, v52, v48, s35
v_perm_b32 v111, v60, v56, s35
v_mfma_f32_16x16x32_bf16 v[64:67], v[100:103], v[104:107], v[64:67]
s_nop 0
v_mfma_f32_16x16x32_bf16 v[68:71], v[100:103], v[108:111], v[68:71]
v_perm_b32 v112, v37, v33, s34
v_perm_b32 v113, v45, v41, s34
v_perm_b32 v114, v53, v49, s34
v_perm_b32 v115, v61, v57, s34
v_perm_b32 v116, v37, v33, s35
v_perm_b32 v117, v45, v41, s35
v_perm_b32 v118, v53, v49, s35
v_perm_b32 v119, v61, v57, s35
v_mfma_f32_16x16x32_bf16 v[72:75], v[100:103], v[112:115], v[72:75]
s_nop 0
v_mfma_f32_16x16x32_bf16 v[76:79], v[100:103], v[116:119], v[76:79]
v_perm_b32 v104, v38, v34, s34
v_perm_b32 v105, v46, v42, s34
v_perm_b32 v106, v54, v50, s34
v_perm_b32 v107, v62, v58, s34
v_perm_b32 v108, v38, v34, s35
v_perm_b32 v109, v46, v42, s35
v_perm_b32 v110, v54, v50, s35
v_perm_b32 v111, v62, v58, s35
v_mfma_f32_16x16x32_bf16 v[80:83], v[100:103], v[104:107], v[80:83]
s_nop 0
v_mfma_f32_16x16x32_bf16 v[84:87], v[100:103], v[108:111], v[84:87]
v_perm_b32 v112, v39, v35, s34
v_perm_b32 v113, v47, v43, s34
v_perm_b32 v114, v55, v51, s34
v_perm_b32 v115, v63, v59, s34
v_perm_b32 v116, v39, v35, s35
v_perm_b32 v117, v47, v43, s35
v_perm_b32 v118, v55, v51, s35
v_perm_b32 v119, v63, v59, s35
v_mfma_f32_16x16x32_bf16 v[88:91], v[100:103], v[112:115], v[88:91]
s_nop 0
v_mfma_f32_16x16x32_bf16 v[92:95], v[100:103], v[116:119], v[92:95]
v_add_f32_dpp v96, v65, v64 row_shl:8 row_mask:0xf bank_mask:0x3
v_add_f32_dpp v97, v69, v68 row_shl:8 row_mask:0xf bank_mask:0x3
s_nop 0
v_add_f32_dpp v96, v66, v67 row_shr:8 row_mask:0xf bank_mask:0xc
v_add_f32_dpp v97, v70, v71 row_shr:8 row_mask:0xf bank_mask:0xc
v_bfi_b32 v96, s3, v124, v96
v_bfi_b32 v97, s3, v124, v97
v_add_f32_dpp v98, v73, v72 row_shl:8 row_mask:0xf bank_mask:0x3
v_add_f32_dpp v99, v77, v76 row_shl:8 row_mask:0xf bank_mask:0x3
s_nop 0
v_add_f32_dpp v98, v74, v75 row_shr:8 row_mask:0xf bank_mask:0xc
v_add_f32_dpp v99, v78, v79 row_shr:8 row_mask:0xf bank_mask:0xc
v_bfi_b32 v98, s3, v124, v98
v_bfi_b32 v99, s3, v124, v99
v_add_f32_dpp v100, v81, v80 row_shl:8 row_mask:0xf bank_mask:0x3
v_add_f32_dpp v101, v85, v84 row_shl:8 row_mask:0xf bank_mask:0x3
s_nop 0
v_add_f32_dpp v100, v82, v83 row_shr:8 row_mask:0xf bank_mask:0xc
v_add_f32_dpp v101, v86, v87 row_shr:8 row_mask:0xf bank_mask:0xc
v_bfi_b32 v100, s3, v124, v100
v_bfi_b32 v101, s3, v124, v101
v_add_f32_dpp v102, v89, v88 row_shl:8 row_mask:0xf bank_mask:0x3
v_add_f32_dpp v103, v93, v92 row_shl:8 row_mask:0xf bank_mask:0x3
s_nop 0
v_add_f32_dpp v102, v90, v91 row_shr:8 row_mask:0xf bank_mask:0xc
v_add_f32_dpp v103, v94, v95 row_shr:8 row_mask:0xf bank_mask:0xc
v_bfi_b32 v102, s3, v124, v102
v_bfi_b32 v103, s3, v124, v103
v_mov_b32 v119, v121
s_mov_b32 s94, s75
s_mov_b32 s66, 3
buffer_store_dwordx4 v[96:99], v121, s[56:59], s75 offen
buffer_store_dwordx4 v[100:103], v121, s[56:59], s75 offen offset:128
s_mov_b64 exec, s[70:71]
buffer_store_dword v122, v123, s[56:59], s76 offen sc1
s_mov_b64 exec, -1
s_branch L_vload
L_f2l:
s_bitcmp0_b32 s65, 1
s_cbranch_scc1 L_vload
s_mov_b32 s44, s18
s_mov_b32 s45, s19
s_mov_b32 s46, 1835008
s_mov_b32 s47, 0x20000
s_setprio 0
s_mov_b32 s66, 1
v_lshl_add_u32 v121, v112, 10, v111
s_lshl_b32 s75, s64, 16
s_lshl_b32 s76, s29, 8
s_add_u32 s75, s75, s76
s_sub_u32 s76, s33, 1
s_lshl_b32 s76, s76, 7
s_add_u32 s75, s75, s76
s_add_u32 s76, s75, 4096
buffer_load_dwordx4 v[64:67], v121, s[44:47], s75 offen offset:0 nt
buffer_load_dwordx4 v[68:71], v121, s[44:47], s75 offen offset:1024 nt
buffer_load_dwordx4 v[72:75], v121, s[44:47], s75 offen offset:2048 nt
buffer_load_dwordx4 v[76:79], v121, s[44:47], s75 offen offset:3072 nt
buffer_load_dwordx4 v[80:83], v121, s[44:47], s76 offen offset:0 nt
buffer_load_dwordx4 v[84:87], v121, s[44:47], s76 offen offset:1024 nt
buffer_load_dwordx4 v[88:91], v121, s[44:47], s76 offen offset:2048 nt
buffer_load_dwordx4 v[92:95], v121, s[44:47], s76 offen offset:3072 nt
s_branch L_vload
L_vload:
s_setprio 0
s_movk_i32 s77, 0x1000
s_add_u32 s55, s78, s53
buffer_load_dwordx4 v[0:3], v120, s[40:43], s55 offen nt
s_add_u32 s53, s53, s77
s_and_b32 s53, s53, s54
s_add_u32 s55, s78, s53
buffer_load_dwordx4 v[4:7], v120, s[40:43], s55 offen nt
s_add_u32 s53, s53, s77
s_and_b32 s53, s53, s54
s_add_u32 s55, s78, s53
buffer_load_dwordx4 v[8:11], v120, s[40:43], s55 offen nt
s_add_u32 s53, s53, s77
s_and_b32 s53, s53, s54
s_add_u32 s55, s78, s53
buffer_load_dwordx4 v[12:15], v120, s[40:43], s55 offen nt
s_add_u32 s53, s53, s77
s_and_b32 s53, s53, s54
s_add_u32 s55, s78, s53
buffer_load_dwordx4 v[16:19], v120, s[40:43], s55 offen nt
s_add_u32 s53, s53, s77
s_and_b32 s53, s53, s54
s_add_u32 s55, s78, s53
buffer_load_dwordx4 v[20:23], v120, s[40:43], s55 offen nt
s_add_u32 s53, s53, s77
s_and_b32 s53, s53, s54
s_add_u32 s55, s78, s53
buffer_load_dwordx4 v[24:27], v120, s[40:43], s55 offen nt
s_add_u32 s53, s53, s77
s_and_b32 s53, s53, s54
s_add_u32 s55, s78, s53
buffer_load_dwordx4 v[28:31], v120, s[40:43], s55 offen nt
s_add_u32 s53, s53, s77
s_and_b32 s53, s53, s54
s_add_u32 s55, s78, s53
buffer_load_dwordx4 v[32:35], v120, s[40:43], s55 offen nt
s_add_u32 s53, s53, s77
s_and_b32 s53, s53, s54
s_add_u32 s55, s78, s53
buffer_load_dwordx4 v[36:39], v120, s[40:43], s55 offen nt
s_add_u32 s53, s53, s77
s_and_b32 s53, s53, s54
s_add_u32 s55, s78, s53
buffer_load_dwordx4 v[40:43], v120, s[40:43], s55 offen nt
s_add_u32 s53, s53, s77
s_and_b32 s53, s53, s54
s_add_u32 s55, s78, s53
buffer_load_dwordx4 v[44:47], v120, s[40:43], s55 offen nt
s_add_u32 s53, s53, s77
s_and_b32 s53, s53, s54
s_add_u32 s55, s78, s53
buffer_load_dwordx4 v[48:51], v120, s[40:43], s55 offen nt
s_add_u32 s53, s53, s77
s_and_b32 s53, s53, s54
s_add_u32 s55, s78, s53
buffer_load_dwordx4 v[52:55], v120, s[40:43], s55 offen nt
s_add_u32 s53, s53, s77
s_and_b32 s53, s53, s54
s_add_u32 s55, s78, s53
buffer_load_dwordx4 v[56:59], v120, s[40:43], s55 offen nt
s_add_u32 s53, s53, s77
s_and_b32 s53, s53, s54
s_add_u32 s55, s78, s53
buffer_load_dwordx4 v[60:63], v120, s[40:43], s55 offen nt
s_add_u32 s53, s53, s77
s_and_b32 s53, s53, s54
s_cmp_lt_u32 s33, 4
s_cbranch_scc1 L_novi
s_waitcnt lgkmcnt(0)
v_mov_b32 v125, 1
s_mov_b64 exec, 1
ds_add_u32 v127, v125 offset:112
s_mov_b64 exec, -1
L_novi:
s_cmp_eq_u32 s66, 0
s_cbranch_scc1 L_noj
s_cmp_lg_u32 s66, 3
s_cbranch_scc1 L_f2w
s_mov_b32 s72, 65536
Lw_15:
ds_read_b32 v125, v127 offset:4
s_waitcnt lgkmcnt(0)
v_readfirstlane_b32 s73, v125
s_nop 0
s_cmp_ge_u32 s73, 1
s_nop 1
s_cbranch_scc1 Ld_16
s_sleep 1
s_sub_u32 s72, s72, 1
s_cmp_lg_u32 s72, 0
s_cbranch_scc1 Lw_15
Ld_16:
s_cmp_eq_u32 s73, 1
s_cbranch_scc1 L_noj
buffer_store_dwordx4 v[96:99], v119, s[56:59], s94 offen sc1
buffer_store_dwordx4 v[100:103], v119, s[56:59], s94 offen offset:128 sc1
s_nop 0
s_branch L_noj
L_f2w:
s_waitcnt vmcnt(16)
L_f2:
v_bfe_u32 v122, v126, 1, 3
v_lshlrev_b32 v122, 7, v122
v_and_b32 v118, 1, v126
v_lshl_add_u32 v122, v118, 4, v122
v_lshrrev_b32 v118, 4, v126
v_lshl_add_u32 v122, v118, 5, v122
v_lshrrev_b32 v121, 3, v126
v_lshlrev_b32 v121, 11, v121
v_and_b32 v123, 7, v126
v_lshl_add_u32 v121, v123, 4, v121
s_lshl_b32 s75, s64, 14
s_lshl_b32 s76, s29, 9
s_add_u32 s75, s75, s76
s_sub_u32 s76, s33, 1
s_lshl_b32 s76, s76, 8
s_add_u32 s75, s75, s76
s_add_u32 s75, s75, 1572864
s_mov_b32 s72, 65536
Lw_17:
ds_read_b32 v125, v127 offset:12
s_waitcnt lgkmcnt(0)
v_readfirstlane_b32 s73, v125
s_nop 0
s_cmp_ge_u32 s73, 1
s_nop 1
s_cbranch_scc1 Ld_18
s_sleep 1
s_sub_u32 s72, s72, 1
s_cmp_lg_u32 s72, 0
s_cbranch_scc1 Lw_17
Ld_18:
ds_read_b128 v[112:115], v122 offset:2048
ds_read_b64 v[124:125], v127 offset:24
s_waitcnt lgkmcnt(0)
v_readfirstlane_b32 s68, v124
v_readfirstlane_b32 s69, v125
s_setprio 3
v_perm_b32 v96, v68, v64, s34
v_perm_b32 v97, v76, v72, s34
v_perm_b32 v98, v84, v80, s34
v_perm_b32 v99, v92, v88, s34
v_perm_b32 v100, v68, v64, s35
v_perm_b32 v101, v76, v72, s35
v_perm_b32 v102, v84, v80, s35
v_perm_b32 v103, v92, v88, s35
v_mfma_f32_16x16x32_bf16 v[104:107], v[112:115], v[96:99], 0
s_nop 0
v_mfma_f32_16x16x32_bf16 v[108:111], v[112:115], v[100:103], 0
s_nop 5
v_add_f32_dpp v116, v105, v104 row_shl:8 row_mask:0xf bank_mask:0x3
s_nop 0
v_add_f32_dpp v117, v109, v108 row_shl:8 row_mask:0xf bank_mask:0x3
v_add_f32_dpp v116, v106, v107 row_shr:8 row_mask:0xf bank_mask:0xc
s_nop 0
v_add_f32_dpp v117, v110, v111 row_shr:8 row_mask:0xf bank_mask:0xc
v_bfi_b32 v116, s52, v124, v116
v_bfi_b32 v117, s52, v124, v117
v_perm_b32 v96, v69, v65, s34
v_perm_b32 v97, v77, v73, s34
v_perm_b32 v98, v85, v81, s34
v_perm_b32 v99, v93, v89, s34
v_perm_b32 v100, v69, v65, s35
v_perm_b32 v101, v77, v73, s35
v_perm_b32 v102, v85, v81, s35
v_perm_b32 v103, v93, v89, s35
v_mfma_f32_16x16x32_bf16 v[104:107], v[112:115], v[96:99], 0
s_nop 0
v_mfma_f32_16x16x32_bf16 v[108:111], v[112:115], v[100:103], 0
s_nop 5
v_add_f32_dpp v118, v105, v104 row_shl:8 row_mask:0xf bank_mask:0x3
s_nop 0
v_add_f32_dpp v119, v109, v108 row_shl:8 row_mask:0xf bank_mask:0x3
v_add_f32_dpp v118, v106, v107 row_shr:8 row_mask:0xf bank_mask:0xc
s_nop 0
v_add_f32_dpp v119, v110, v111 row_shr:8 row_mask:0xf bank_mask:0xc
v_bfi_b32 v118, s52, v124, v118
v_bfi_b32 v119, s52, v124, v119
buffer_store_dwordx4 v[116:119], v121, s[56:59], s75 offen offset:0 sc1
v_perm_b32 v96, v70, v66, s34
v_perm_b32 v97, v78, v74, s34
v_perm_b32 v98, v86, v82, s34
v_perm_b32 v99, v94, v90, s34
v_perm_b32 v100, v70, v66, s35
v_perm_b32 v101, v78, v74, s35
v_perm_b32 v102, v86, v82, s35
v_perm_b32 v103, v94, v90, s35
v_mfma_f32_16x16x32_bf16 v[104:107], v[112:115], v[96:99], 0
s_nop 0
v_mfma_f32_16x16x32_bf16 v[108:111], v[112:115], v[100:103], 0
s_nop 5
v_add_f32_dpp v116, v105, v104 row_shl:8 row_mask:0xf bank_mask:0x3
s_nop 0
v_add_f32_dpp v117, v109, v108 row_shl:8 row_mask:0xf bank_mask:0x3
v_add_f32_dpp v116, v106, v107 row_shr:8 row_mask:0xf bank_mask:0xc
s_nop 0
v_add_f32_dpp v117, v110, v111 row_shr:8 row_mask:0xf bank_mask:0xc
v_bfi_b32 v116, s52, v124, v116
v_bfi_b32 v117, s52, v124, v117
v_perm_b32 v96, v71, v67, s34
v_perm_b32 v97, v79, v75, s34
v_perm_b32 v98, v87, v83, s34
v_perm_b32 v99, v95, v91, s34
v_perm_b32 v100, v71, v67, s35
v_perm_b32 v101, v79, v75, s35
v_perm_b32 v102, v87, v83, s35
v_perm_b32 v103, v95, v91, s35
v_mfma_f32_16x16x32_bf16 v[104:107], v[112:115], v[96:99], 0
s_nop 0
v_mfma_f32_16x16x32_bf16 v[108:111], v[112:115], v[100:103], 0
s_nop 5
v_add_f32_dpp v118, v105, v104 row_shl:8 row_mask:0xf bank_mask:0x3
s_nop 0
v_add_f32_dpp v119, v109, v108 row_shl:8 row_mask:0xf bank_mask:0x3
v_add_f32_dpp v118, v106, v107 row_shr:8 row_mask:0xf bank_mask:0xc
s_nop 0
v_add_f32_dpp v119, v110, v111 row_shr:8 row_mask:0xf bank_mask:0xc
v_bfi_b32 v118, s52, v124, v118
v_bfi_b32 v119, s52, v124, v119
buffer_store_dwordx4 v[116:119], v121, s[56:59], s75 offen offset:128 sc1
s_setprio 0
L_noj:
v_lshrrev_b32 v108, 4, v126
v_and_b32 v110, 3, v126
v_bfe_u32 v109, v126, 2, 2
v_lshlrev_b32 v122, 7, v110
v_lshl_add_u32 v122, v108, 5, v122
s_lshl_b32 s75, s33, 9
s_add_u32 s75, s75, 3072
v_add_u32 v122, s75, v122
v_mov_b32 v123, 64
v_cmp_eq_u32 vcc, 0, v109
s_nop 1
v_cndmask_b32 v112, v123, v122, vcc
v_cmp_eq_u32 vcc, 1, v109
s_nop 1
v_cndmask_b32 v113, v123, v122, vcc
v_cmp_eq_u32 vcc, 2, v109
s_nop 1
v_cndmask_b32 v114, v123, v122, vcc
v_cmp_eq_u32 vcc, 3, v109
s_nop 1
v_cndmask_b32 v115, v123, v122, vcc
s_lshl_b32 s75, s33, 2
v_mov_b32 v123, s75
s_and_b32 s75, s33, 3
s_lshl_b32 s76, s75, 2
v_mov_b32 v121, s76
s_lshl_b32 s75, s75, 11
v_add_u32 v120, s75, v120
v_lshlrev_b32 v122, 2, v126
v_add_u32 v122, s75, v122
s_mov_b32 s72, 65536
Lw_19:
ds_read_b32 v125, v123 offset:32
s_waitcnt lgkmcnt(0)
v_readfirstlane_b32 s73, v125
s_nop 0
s_cmp_ge_u32 s73, 1
s_nop 1
s_cbranch_scc1 Ld_20
s_sleep 1
s_sub_u32 s72, s72, 1
s_cmp_lg_u32 s72, 0
s_cbranch_scc1 Lw_19
Ld_20:
ds_read_b128 v[64:67], v112 offset:0
ds_read_b128 v[68:71], v113 offset:0
ds_read_b128 v[72:75], v114 offset:0
ds_read_b128 v[76:79], v115 offset:0
ds_read_b128 v[80:83], v112 offset:16
ds_read_b128 v[84:87], v113 offset:16
ds_read_b128 v[88:91], v114 offset:16
ds_read_b128 v[92:95], v115 offset:16
s_cmp_ge_u32 s33, 4
s_cbranch_scc1 L_g3
v_mov_b32 v96, 0
v_mov_b32 v97, 0
v_mov_b32 v98, 0
v_mov_b32 v99, 0
v_mov_b32 v100, 0
v_mov_b32 v101, 0
v_mov_b32 v102, 0
v_mov_b32 v103, 0
s_nop 0
s_branch L_pv
L_g3:
s_mov_b32 s72, 65536
Lw_21:
ds_read_b32 v125, v121 offset:96
s_waitcnt lgkmcnt(0)
v_readfirstlane_b32 s73, v125
s_nop 0
s_cmp_ge_u32 s73, 1
s_nop 1
s_cbranch_scc1 Ld_22
s_sleep 1
s_sub_u32 s72, s72, 1
s_cmp_lg_u32 s72, 0
s_cbranch_scc1 Lw_21
Ld_22:
ds_read_b128 v[96:99], v120 offset:23552
ds_read_b128 v[100:103], v120 offset:24576
s_mov_b32 s44, s12
s_mov_b32 s45, s13
s_mov_b32 s46, 4194304
s_mov_b32 s47, 0x20000
v_bfe_u32 v116, v126, 3, 1
v_lshlrev_b32 v116, 6, v116
v_lshrrev_b32 v117, 4, v126
v_add_u32 v116, v116, v117
v_and_b32 v117, 7, v126
v_lshlrev_b32 v117, 4, v117
v_lshl_add_u32 v116, v116, 10, v117
s_lshl_b32 s75, s30, 17
s_lshl_b32 s76, s49, 7
s_add_u32 s75, s75, s76
s_bfe_u32 s76, s33, 0x10001
s_lshl_b32 s76, s76, 12
s_add_u32 s75, s75, s76
s_and_b32 s76, s33, 1
s_lshl_b32 s76, s76, 15
s_add_u32 s75, s75, s76
s_and_b32 s77, s33, 3
s_lshl_b32 s77, s77, 12
s_add_u32 m0, s77, 33792
s_mov_b32 s72, 65536
Lw_23:
ds_read_b32 v125, v127 offset:112
s_waitcnt lgkmcnt(0)
v_readfirstlane_b32 s73, v125
s_nop 0
s_cmp_ge_u32 s73, 4
s_nop 1
s_cbranch_scc1 Ld_24
s_sleep 1
s_sub_u32 s72, s72, 1
s_cmp_lg_u32 s72, 0
s_cbranch_scc1 Lw_23
Ld_24:
buffer_load_dwordx4 v116, s[44:47], s75 offen nt lds
s_add_u32 m0, m0, 0x400
s_add_u32 s75, s75, 0x2000
buffer_load_dwordx4 v116, s[44:47], s75 offen nt lds
s_add_u32 m0, m0, 0x400
s_add_u32 s75, s75, 0x2000
buffer_load_dwordx4 v116, s[44:47], s75 offen nt lds
s_add_u32 m0, m0, 0x400
s_add_u32 s75, s75, 0x2000
buffer_load_dwordx4 v116, s[44:47], s75 offen nt lds
s_add_u32 m0, m0, 0x400
s_add_u32 s75, s75, 0x2000
s_waitcnt lgkmcnt(0)
v_mov_b32 v125, 1
s_mov_b64 exec, 1
ds_add_u32 v127, v125 offset:112
s_mov_b64 exec, -1
L_pv:
s_waitcnt lgkmcnt(0)
s_cmp_ge_u32 s33, 4
s_cbranch_scc1 Lv_25
s_waitcnt vmcnt(8)
Lv_25:
s_waitcnt vmcnt(12)
v_perm_b32 v104, v4, v0, s34
v_perm_b32 v105, v12, v8, s34
v_perm_b32 v106, v20, v16, s34
v_perm_b32 v107, v28, v24, s34
v_perm_b32 v108, v4, v0, s35
v_perm_b32 v109, v12, v8, s35
v_perm_b32 v110, v20, v16, s35
v_perm_b32 v111, v28, v24, s35
v_mfma_f32_16x16x32_bf16 v[96:99], v[64:67], v[104:107], v[96:99]
s_nop 0
v_mfma_f32_16x16x32_bf16 v[96:99], v[68:71], v[108:111], v[96:99]
v_perm_b32 v112, v5, v1, s34
v_perm_b32 v113, v13, v9, s34
v_perm_b32 v114, v21, v17, s34
v_perm_b32 v115, v29, v25, s34
v_perm_b32 v116, v5, v1, s35
v_perm_b32 v117, v13, v9, s35
v_perm_b32 v118, v21, v17, s35
v_perm_b32 v119, v29, v25, s35
v_mfma_f32_16x16x32_bf16 v[96:99], v[72:75], v[112:115], v[96:99]
s_nop 0
v_mfma_f32_16x16x32_bf16 v[96:99], v[76:79], v[116:119], v[96:99]
v_perm_b32 v104, v6, v2, s34
v_perm_b32 v105, v14, v10, s34
v_perm_b32 v106, v22, v18, s34
v_perm_b32 v107, v30, v26, s34
v_perm_b32 v108, v6, v2, s35
v_perm_b32 v109, v14, v10, s35
v_perm_b32 v110, v22, v18, s35
v_perm_b32 v111, v30, v26, s35
v_mfma_f32_16x16x32_bf16 v[100:103], v[64:67], v[104:107], v[100:103]
s_nop 0
v_mfma_f32_16x16x32_bf16 v[100:103], v[68:71], v[108:111], v[100:103]
v_perm_b32 v112, v7, v3, s34
v_perm_b32 v113, v15, v11, s34
v_perm_b32 v114, v23, v19, s34
v_perm_b32 v115, v31, v27, s34
v_perm_b32 v116, v7, v3, s35
v_perm_b32 v117, v15, v11, s35
v_perm_b32 v118, v23, v19, s35
v_perm_b32 v119, v31, v27, s35
v_mfma_f32_16x16x32_bf16 v[100:103], v[72:75], v[112:115], v[100:103]
s_nop 0
v_mfma_f32_16x16x32_bf16 v[100:103], v[76:79], v[116:119], v[100:103]
ds_read_b64 v[124:125], v127 offset:24
s_waitcnt lgkmcnt(0)
v_readfirstlane_b32 s68, v124
v_readfirstlane_b32 s69, v125
v_bfe_u32 v116, v126, 1, 3
v_lshlrev_b32 v116, 8, v116
v_and_b32 v118, 1, v126
v_lshl_add_u32 v116, v118, 4, v116
v_lshrrev_b32 v118, 4, v126
v_lshl_add_u32 v116, v118, 5, v116
s_and_b32 s77, s33, 3
s_lshl_b32 s76, s77, 2
v_lshlrev_b32 v117, 4, v126
v_add_u32 v117, s76, v117
v_lshrrev_b32 v119, 3, v126
v_lshlrev_b32 v119, 16, v119
v_and_b32 v118, 7, v126
v_lshl_add_u32 v119, v118, 3, v119
s_lshl_b32 s86, s30, 11
s_lshl_b32 s76, s49, 8
s_add_u32 s86, s86, s76
s_lshl_b32 s76, s77, 6
s_add_u32 s86, s86, s76
s_add_u32 s86, s86, 1048576
s_cmp_ge_u32 s33, 4
s_cbranch_scc1 Lv_26
s_waitcnt vmcnt(6)
Lv_26:
s_waitcnt vmcnt(10)
v_perm_b32 v0, v36, v32, s34
v_perm_b32 v4, v36, v32, s35
v_perm_b32 v8, v37, v33, s34
v_perm_b32 v12, v37, v33, s35
v_perm_b32 v16, v38, v34, s34
v_perm_b32 v20, v38, v34, s35
v_perm_b32 v24, v39, v35, s34
v_perm_b32 v28, v39, v35, s35
s_nop 0
s_cbranch_scc1 Lv_27
s_waitcnt vmcnt(4)
Lv_27:
s_waitcnt vmcnt(8)
v_perm_b32 v1, v44, v40, s34
v_perm_b32 v5, v44, v40, s35
v_perm_b32 v9, v45, v41, s34
v_perm_b32 v13, v45, v41, s35
v_perm_b32 v17, v46, v42, s34
v_perm_b32 v21, v46, v42, s35
v_perm_b32 v25, v47, v43, s34
v_perm_b32 v29, v47, v43, s35
s_nop 0
s_cbranch_scc1 Lv_28
s_waitcnt vmcnt(2)
Lv_28:
s_waitcnt vmcnt(6)
v_perm_b32 v2, v52, v48, s34
v_perm_b32 v6, v52, v48, s35
v_perm_b32 v10, v53, v49, s34
v_perm_b32 v14, v53, v49, s35
v_perm_b32 v18, v54, v50, s34
v_perm_b32 v22, v54, v50, s35
v_perm_b32 v26, v55, v51, s34
v_perm_b32 v30, v55, v51, s35
s_nop 0
s_cbranch_scc1 Lv_29
s_waitcnt vmcnt(0)
Lv_29:
s_waitcnt vmcnt(4)
v_perm_b32 v3, v60, v56, s34
v_perm_b32 v7, v60, v56, s35
v_perm_b32 v11, v61, v57, s34
v_perm_b32 v15, v61, v57, s35
v_mfma_f32_16x16x32_bf16 v[96:99], v[80:83], v[0:3], v[96:99]
v_mfma_f32_16x16x32_bf16 v[96:99], v[84:87], v[4:7], v[96:99]
v_perm_b32 v19, v62, v58, s34
v_perm_b32 v23, v62, v58, s35
v_mfma_f32_16x16x32_bf16 v[96:99], v[88:91], v[8:11], v[96:99]
v_mfma_f32_16x16x32_bf16 v[96:99], v[92:95], v[12:15], v[96:99]
v_perm_b32 v27, v63, v59, s34
v_perm_b32 v31, v63, v59, s35
v_mfma_f32_16x16x32_bf16 v[100:103], v[80:83], v[16:19], v[100:103]
v_mfma_f32_16x16x32_bf16 v[100:103], v[84:87], v[20:23], v[100:103]
v_mfma_f32_16x16x32_bf16 v[100:103], v[88:91], v[24:27], v[100:103]
v_mfma_f32_16x16x32_bf16 v[100:103], v[92:95], v[28:31], v[100:103]
s_cmp_ge_u32 s33, 4
s_nop 5
s_cbranch_scc1 L_g3b
ds_write_b128 v120, v[96:99] offset:23552
ds_write_b128 v120, v[100:103] offset:24576
s_waitcnt lgkmcnt(0)
v_mov_b32 v125, 1
s_mov_b64 exec, 1
ds_add_u32 v121, v125 offset:96
s_mov_b64 exec, -1
s_endpgm
L_g3b:
ds_write_b32 v122, v96 offset:15360
ds_write_b32 v122, v97 offset:15872
ds_write_b32 v122, v98 offset:16384
ds_write_b32 v122, v99 offset:16896
ds_write_b32 v122, v100 offset:15616
ds_write_b32 v122, v101 offset:16128
ds_write_b32 v122, v102 offset:16640
ds_write_b32 v122, v103 offset:17152
s_waitcnt lgkmcnt(0)
s_barrier
s_waitcnt vmcnt(0)
s_waitcnt lgkmcnt(0)
v_mov_b32 v125, 1
s_mov_b64 exec, 1
ds_add_u32 v127, v125 offset:116
s_mov_b64 exec, -1
s_mov_b32 s72, 65536
Lw_30:
ds_read_b32 v125, v127 offset:116
s_waitcnt lgkmcnt(0)
v_readfirstlane_b32 s73, v125
s_nop 0
s_cmp_ge_u32 s73, 4
s_nop 1
s_cbranch_scc1 Ld_31
s_nop 0
s_sub_u32 s72, s72, 1
s_cmp_lg_u32 s72, 0
s_cbranch_scc1 Lw_30
Ld_31:
ds_read_b32 v0, v117 offset:33792
ds_read_b32 v1, v117 offset:34816
ds_read_b32 v2, v117 offset:35840
ds_read_b32 v3, v117 offset:36864
ds_read_b32 v4, v117 offset:37888
ds_read_b32 v5, v117 offset:38912
ds_read_b32 v6, v117 offset:39936
ds_read_b32 v7, v117 offset:40960
ds_read_b32 v8, v117 offset:41984
ds_read_b32 v9, v117 offset:43008
ds_read_b32 v10, v117 offset:44032
ds_read_b32 v11, v117 offset:45056
ds_read_b32 v12, v117 offset:46080
ds_read_b32 v13, v117 offset:47104
ds_read_b32 v14, v117 offset:48128
ds_read_b32 v15, v117 offset:49152
s_waitcnt lgkmcnt(8)
v_perm_b32 v16, v1, v0, s34
v_perm_b32 v20, v1, v0, s35
v_perm_b32 v17, v3, v2, s34
v_perm_b32 v21, v3, v2, s35
v_perm_b32 v18, v5, v4, s34
v_perm_b32 v22, v5, v4, s35
v_perm_b32 v19, v7, v6, s34
v_perm_b32 v23, v7, v6, s35
s_waitcnt lgkmcnt(0)
v_perm_b32 v24, v9, v8, s34
v_perm_b32 v28, v9, v8, s35
v_perm_b32 v25, v11, v10, s34
v_perm_b32 v29, v11, v10, s35
v_perm_b32 v26, v13, v12, s34
v_perm_b32 v30, v13, v12, s35
v_perm_b32 v27, v15, v14, s34
v_perm_b32 v31, v15, v14, s35
s_barrier
ds_read_b128 v[96:99], v116 offset:31744
ds_read_b128 v[100:103], v116 offset:31872
s_waitcnt lgkmcnt(1)
v_mfma_f32_16x16x32_bf16 v[104:107], v[96:99], v[16:19], 0
v_mfma_f32_16x16x32_bf16 v[108:111], v[96:99], v[20:23], 0
s_waitcnt lgkmcnt(0)
v_mfma_f32_16x16x32_bf16 v[104:107], v[100:103], v[24:27], v[104:107]
v_mfma_f32_16x16x32_bf16 v[108:111], v[100:103], v[28:31], v[108:111]
s_nop 6
v_add_f32_dpp v112, v105, v104 row_shl:8 row_mask:0xf bank_mask:0x3
v_add_f32_dpp v113, v109, v108 row_shl:8 row_mask:0xf bank_mask:0x3
s_nop 0
v_add_f32_dpp v112, v106, v107 row_shr:8 row_mask:0xf bank_mask:0xc
v_add_f32_dpp v113, v110, v111 row_shr:8 row_mask:0xf bank_mask:0xc
v_bfi_b32 v112, s52, v124, v112
v_bfi_b32 v113, s52, v124, v113
buffer_store_dwordx2 v[112:113], v119, s[56:59], s86 offen sc1
L_end:
s_endpgm
L_codeend:
.section .rodata,"a"
.p2align 6
.amdhsa_kernel parallel_sum__sliding_block_cached__dense_activation_relu__decode_kernel
  .amdhsa_next_free_vgpr 128
  .amdhsa_next_free_sgpr 102
  .amdhsa_accum_offset 128
  .amdhsa_group_segment_fixed_size 0
  .amdhsa_kernarg_size 88
  .amdhsa_user_sgpr_count 2
  .amdhsa_user_sgpr_kernarg_segment_ptr 1
  .amdhsa_system_sgpr_workgroup_id_x 1
  .amdhsa_float_denorm_mode_32 3
.end_amdhsa_kernel
```
